```python
import torch

def _softmax(x, axis=-1):
    return torch.softmax(x, dim=axis)
def _gelu(x):
    return torch.nn.functional.gelu(x, approximate="tanh")
def _silu(x):
    return torch.nn.functional.silu(x)
def _sigmoid(x):
    return torch.sigmoid(x)
def _layernorm(x, axis=-1, eps=1e-5):
    m = x.mean(dim=axis, keepdim=True)
    v = x.var(dim=axis, keepdim=True, unbiased=False)
    return (x - m) / torch.sqrt(v + eps)
def _scatter_add(tgt, idx, src, axis=0):
    return tgt.clone().index_add_(axis, idx, src)
def _segment_sum(src, seg, n):
    out = torch.zeros((n,) + src.shape[1:], dtype=src.dtype)
    return out.index_add_(0, seg, src)
def _pad(x, pw):
    flat = tuple(v for pair in reversed(pw) for v in pair)
    return torch.nn.functional.pad(x, flat)

kernel_name = 'concat_heads__grouped_kv_mqa__spectral_fnet__prompt'

def setup_inputs():

    _w = (lambda a: (lambda t: t.to(torch.bfloat16) if t.is_floating_point() else t)(torch.as_tensor(a)))
    def _A_setup():
        B, S, D, H = 1, 2048, 1024, 32
        Dh = D // H
        return {
            "x": _w((lambda *s: torch.randn(*s, dtype=torch.bfloat16) * 0.05)(B, S, D)),
            "wq": _w((lambda *s: torch.randn(*s, dtype=torch.bfloat16) * 3.2)(D, H * Dh)),
            "wk": _w((lambda *s: torch.randn(*s, dtype=torch.bfloat16) * 3.2)(D, Dh)),
            "wv": _w((lambda *s: torch.randn(*s, dtype=torch.bfloat16) * 0.4)(D, Dh)),
            "wo": _w((lambda *s: torch.randn(*s, dtype=torch.bfloat16) * 0.4)(H * Dh, D)),
        }
    _A_in = _A_setup()

    def _B_setup():
        B, S, D = 1, 2048, 1024
        ns = torch.arange(S)[:, None] * torch.arange(S)[None, :]
        nd = torch.arange(D)[:, None] * torch.arange(D)[None, :]
        Ws_re = torch.cos(-2.0 * torch.pi * ns / S).to(float)
        Ws_im = torch.sin(-2.0 * torch.pi * ns / S).to(float)
        Wd_re = torch.cos(-2.0 * torch.pi * nd / D).to(float)
        Wd_im = torch.sin(-2.0 * torch.pi * nd / D).to(float)
        return {
            "x": _w((lambda *s: torch.randn(*s, dtype=torch.bfloat16) * 0.05)(B, S, D)),
            "dft_seq_re": _w(Ws_re),
            "dft_seq_im": _w(Ws_im),
            "dft_hid_re": _w(Wd_re),
            "dft_hid_im": _w(Wd_im),
        }
    _B_in = _B_setup()

    return {
        "A_x": _A_in["x"],
        "A_wq": _A_in["wq"],
        "A_wk": _A_in["wk"],
        "A_wv": _A_in["wv"],
        "A_wo": _A_in["wo"],
        "B_x": _B_in["x"],
        "B_dft_seq_re": _B_in["dft_seq_re"],
        "B_dft_seq_im": _B_in["dft_seq_im"],
        "B_dft_hid_re": _B_in["dft_hid_re"],
        "B_dft_hid_im": _B_in["dft_hid_im"],
    }

def reference(A_x, A_wq, A_wk, A_wv, A_wo, B_x, B_dft_seq_re, B_dft_seq_im, B_dft_hid_re, B_dft_hid_im):
    def _A_ref(x, wq, wk, wv, wo):
        B, S, D = x.shape
        H = 32
        Dh = D // H
        q = (lambda x, *d: x.permute(*d))((x @ wq).reshape(B, S, H, Dh), 0, 2, 1, 3)
        k = x @ wk
        v = x @ wv
        scores = torch.einsum("bhqd,bkd->bhqk", q, k) * (Dh ** -0.5)
        p = _softmax(scores, axis=-1)
        o = torch.einsum("bhqk,bkd->bhqd", p, v)
        return (lambda x, *d: x.permute(*d))(o, 0, 2, 1, 3).reshape(B, S, H * Dh) @ wo

    def _B_ref(x, dft_seq_re, dft_seq_im, dft_hid_re, dft_hid_im):
        a = torch.einsum("bsd,ed->bse", x, dft_hid_re)
        b = torch.einsum("bsd,ed->bse", x, dft_hid_im)
        y = torch.einsum("ts,bse->bte", dft_seq_re, a) - torch.einsum("ts,bse->bte", dft_seq_im, b)
        return y

    a = _A_ref(A_x, A_wq, A_wk, A_wv, A_wo)
    b = _B_ref(B_x, B_dft_seq_re, B_dft_seq_im, B_dft_hid_re, B_dft_hid_im)
    return torch.concatenate([a, b], axis=-1)
```

```asm
; @launch kernel=attn_kernel grid=(256,1,1) block=(768,1,1) lds=163840
; @launch kernel=outp_kernel grid=(256,1,1) block=(512,1,1) lds=163840
.amdgcn_target "amdgcn-amd-amdhsa--gfx950"
.text
.globl attn_kernel
.p2align 8
.type attn_kernel,@function
attn_kernel:
  s_cmp_ge_u32 s2, 256
  s_cbranch_scc1 L_end_1
  s_load_dwordx2 s[14:15], s[0:1], 96
  s_load_dwordx4 s[4:7], s[0:1], 64
  s_load_dwordx4 s[8:11], s[0:1], 48
  s_load_dwordx2 s[12:13], s[0:1], 32
  s_load_dwordx4 s[96:99], s[0:1], 0
  s_load_dwordx4 s[56:59], s[0:1], 16
  s_load_dwordx2 s[100:101], s[0:1], 40
  s_load_dwordx2 s[62:63], s[0:1], 88
  v_lshrrev_b32 v1, 6, v0
  v_and_b32 v4, 63, v0
  v_readfirstlane_b32 s42, v1
  s_and_b32 s65, s2, 7
  s_lshr_b32 s66, s2, 3
  s_lshl_b32 s67, s65, 1
  s_lshr_b32 s64, s66, 4
  s_add_u32 s67, s67, s64
  s_and_b32 s68, s66, 15
  s_and_b32 s69, s42, 3
  s_bfe_u32 s70, s42, 0x10002
  s_lshl_b32 s43, s67, 2
  s_add_u32 s43, s43, s69
  s_lshl_b32 s43, s43, 5
  s_lshl_b32 s64, s68, 1
  s_add_u32 s43, s43, s64
  s_add_u32 s43, s43, s70
  s_lshl_b32 s43, s43, 11
  v_lshlrev_b32 v5, 4, v4
  s_lshl_b32 s44, s42, 11
  s_waitcnt lgkmcnt(0)
  s_mov_b32 s32, s14
  s_mov_b32 s33, s15
  s_mov_b32 s34, 268435456
  s_mov_b32 s35, 0x20000
  s_add_u32 s36, s14, 4194304
  s_addc_u32 s37, s15, 0
  s_mov_b32 s38, 262144
  s_mov_b32 s39, 0x20000
  s_bfe_u32 s53, s65, 0x10001
  s_lshl_b32 s50, s53, 2
  s_lshr_b32 s53, s65, 2
  s_lshl_b32 s53, s53, 1
  s_add_u32 s50, s50, s53
  s_and_b32 s53, s65, 1
  s_add_u32 s50, s50, s53
  s_mov_b32 s64, 0x55555556
  s_mul_hi_u32 s51, s66, s64
  s_mul_i32 s54, s51, 3
  s_sub_u32 s52, s66, s54
  s_cmp_lt_u32 s42, 8
  s_cbranch_scc1 L_comp_2
  s_mov_b32 s24, s96
  s_mov_b32 s25, s97
  s_mov_b32 s26, 4194304
  s_mov_b32 s27, 0x20000
  s_mov_b32 s28, s98
  s_mov_b32 s29, s99
  s_mov_b32 s30, 2097152
  s_mov_b32 s31, 0x20000
  v_lshrrev_b32 v1, 4, v4
  v_and_b32 v2, 7, v4
  v_xor_b32 v1, v1, v2
  v_lshlrev_b32 v1, 4, v1
  v_lshrrev_b32 v2, 3, v4
  v_lshl_add_u32 v40, v2, 11, v1
  v_lshrrev_b32 v1, 4, v4
  v_add_u32 v1, 4, v1
  v_and_b32 v2, 7, v4
  v_xor_b32 v1, v1, v2
  v_lshlrev_b32 v1, 4, v1
  v_lshrrev_b32 v2, 3, v4
  v_lshl_add_u32 v41, v2, 11, v1
  v_add_u32 v41, 16384, v41
  v_lshrrev_b32 v1, 4, v4
  v_and_b32 v2, 7, v4
  v_xor_b32 v1, v1, v2
  v_lshlrev_b32 v1, 4, v1
  v_lshrrev_b32 v2, 3, v4
  v_lshl_add_u32 v42, v2, 11, v1
  v_add_u32 v42, 32768, v42
  v_lshrrev_b32 v1, 4, v4
  v_add_u32 v1, 4, v1
  v_and_b32 v2, 7, v4
  v_xor_b32 v1, v1, v2
  v_lshlrev_b32 v1, 4, v1
  v_lshrrev_b32 v2, 3, v4
  v_lshl_add_u32 v43, v2, 11, v1
  v_add_u32 v43, 49152, v43
  v_bfe_u32 v1, v4, 4, 1
  v_lshlrev_b32 v1, 2, v1
  v_and_b32 v2, 7, v4
  v_xor_b32 v1, v1, v2
  v_lshlrev_b32 v1, 4, v1
  v_lshrrev_b32 v2, 3, v4
  v_lshl_add_u32 v44, v2, 11, v1
  v_add_u32 v45, 16384, v44
  s_lshl_b32 s58, s67, 18
  s_lshl_b32 s64, s69, 16
  s_add_u32 s58, s58, s64
  s_lshl_b32 s59, s68, 7
  s_lshl_b32 s64, s69, 15
  s_add_u32 s59, s59, s64
  s_lshl_b32 s60, s69, 12
  s_add_u32 s60, s60, 49152
  s_lshl_b32 s61, s69, 11
  s_add_u32 s61, s61, 49152
  s_lshr_b32 s71, s66, 4
  s_lshl_b32 s71, s71, 3
  s_add_u32 s71, s71, s66
  s_and_b32 s71, s71, 15
  s_mov_b32 s72, 0
  s_lshl_b32 s74, s71, 7
  s_add_u32 s74, s74, s58
  s_add_u32 s75, s60, s72
  s_add_u32 m0, s75, 0
  s_nop 0
  buffer_load_dwordx4 v40, s[24:27], s74 offen lds
  s_add_u32 m0, s75, 1024
  s_nop 0
  buffer_load_dwordx4 v41, s[24:27], s74 offen lds
  s_add_u32 m0, s75, 2048
  s_nop 0
  buffer_load_dwordx4 v42, s[24:27], s74 offen lds
  s_add_u32 m0, s75, 3072
  s_nop 0
  buffer_load_dwordx4 v43, s[24:27], s74 offen lds
  s_lshl_b32 s74, s71, 17
  s_add_u32 s74, s74, s59
  s_add_u32 s75, s61, s72
  s_add_u32 m0, s75, 16384
  s_nop 0
  buffer_load_dwordx4 v44, s[28:31], s74 offen lds
  s_add_u32 m0, s75, 17408
  s_nop 0
  buffer_load_dwordx4 v45, s[28:31], s74 offen lds
  s_add_u32 s71, s71, 1
  s_and_b32 s71, s71, 15
  s_add_u32 s72, s72, 24576
  s_cmp_eq_u32 s72, 98304
  s_cselect_b32 s72, 0, s72
  s_lshl_b32 s74, s71, 7
  s_add_u32 s74, s74, s58
  s_add_u32 s75, s60, s72
  s_add_u32 m0, s75, 0
  s_nop 0
  buffer_load_dwordx4 v40, s[24:27], s74 offen lds
  s_add_u32 m0, s75, 1024
  s_nop 0
  buffer_load_dwordx4 v41, s[24:27], s74 offen lds
  s_add_u32 m0, s75, 2048
  s_nop 0
  buffer_load_dwordx4 v42, s[24:27], s74 offen lds
  s_add_u32 m0, s75, 3072
  s_nop 0
  buffer_load_dwordx4 v43, s[24:27], s74 offen lds
  s_lshl_b32 s74, s71, 17
  s_add_u32 s74, s74, s59
  s_add_u32 s75, s61, s72
  s_add_u32 m0, s75, 16384
  s_nop 0
  buffer_load_dwordx4 v44, s[28:31], s74 offen lds
  s_add_u32 m0, s75, 17408
  s_nop 0
  buffer_load_dwordx4 v45, s[28:31], s74 offen lds
  s_add_u32 s71, s71, 1
  s_and_b32 s71, s71, 15
  s_add_u32 s72, s72, 24576
  s_cmp_eq_u32 s72, 98304
  s_cselect_b32 s72, 0, s72
  s_lshl_b32 s74, s71, 7
  s_add_u32 s74, s74, s58
  s_add_u32 s75, s60, s72
  s_add_u32 m0, s75, 0
  s_nop 0
  buffer_load_dwordx4 v40, s[24:27], s74 offen lds
  s_add_u32 m0, s75, 1024
  s_nop 0
  buffer_load_dwordx4 v41, s[24:27], s74 offen lds
  s_add_u32 m0, s75, 2048
  s_nop 0
  buffer_load_dwordx4 v42, s[24:27], s74 offen lds
  s_add_u32 m0, s75, 3072
  s_nop 0
  buffer_load_dwordx4 v43, s[24:27], s74 offen lds
  s_lshl_b32 s74, s71, 17
  s_add_u32 s74, s74, s59
  s_add_u32 s75, s61, s72
  s_add_u32 m0, s75, 16384
  s_nop 0
  buffer_load_dwordx4 v44, s[28:31], s74 offen lds
  s_add_u32 m0, s75, 17408
  s_nop 0
  buffer_load_dwordx4 v45, s[28:31], s74 offen lds
  s_add_u32 s71, s71, 1
  s_and_b32 s71, s71, 15
  s_add_u32 s72, s72, 24576
  s_cmp_eq_u32 s72, 98304
  s_cselect_b32 s72, 0, s72
  s_lshl_b32 s74, s71, 7
  s_add_u32 s74, s74, s58
  s_add_u32 s75, s60, s72
  s_add_u32 m0, s75, 0
  s_nop 0
  buffer_load_dwordx4 v40, s[24:27], s74 offen lds
  s_add_u32 m0, s75, 1024
  s_nop 0
  buffer_load_dwordx4 v41, s[24:27], s74 offen lds
  s_add_u32 m0, s75, 2048
  s_nop 0
  buffer_load_dwordx4 v42, s[24:27], s74 offen lds
  s_add_u32 m0, s75, 3072
  s_nop 0
  buffer_load_dwordx4 v43, s[24:27], s74 offen lds
  s_lshl_b32 s74, s71, 17
  s_add_u32 s74, s74, s59
  s_add_u32 s75, s61, s72
  s_add_u32 m0, s75, 16384
  s_nop 0
  buffer_load_dwordx4 v44, s[28:31], s74 offen lds
  s_add_u32 m0, s75, 17408
  s_nop 0
  buffer_load_dwordx4 v45, s[28:31], s74 offen lds
  s_add_u32 s71, s71, 1
  s_and_b32 s71, s71, 15
  s_add_u32 s72, s72, 24576
  s_cmp_eq_u32 s72, 98304
  s_cselect_b32 s72, 0, s72
  s_barrier
  s_waitcnt vmcnt(18)
  s_barrier
  s_waitcnt vmcnt(12)
  s_barrier
  s_mov_b32 s73, 0
L_ll_3:
  s_waitcnt vmcnt(6)
  s_barrier
  s_lshl_b32 s74, s71, 7
  s_add_u32 s74, s74, s58
  s_add_u32 s75, s60, s72
  s_add_u32 m0, s75, 0
  s_nop 0
  buffer_load_dwordx4 v40, s[24:27], s74 offen lds
  s_add_u32 m0, s75, 1024
  s_nop 0
  buffer_load_dwordx4 v41, s[24:27], s74 offen lds
  s_add_u32 m0, s75, 2048
  s_nop 0
  buffer_load_dwordx4 v42, s[24:27], s74 offen lds
  s_add_u32 m0, s75, 3072
  s_nop 0
  buffer_load_dwordx4 v43, s[24:27], s74 offen lds
  s_lshl_b32 s74, s71, 17
  s_add_u32 s74, s74, s59
  s_add_u32 s75, s61, s72
  s_add_u32 m0, s75, 16384
  s_nop 0
  buffer_load_dwordx4 v44, s[28:31], s74 offen lds
  s_add_u32 m0, s75, 17408
  s_nop 0
  buffer_load_dwordx4 v45, s[28:31], s74 offen lds
  s_add_u32 s71, s71, 1
  s_and_b32 s71, s71, 15
  s_add_u32 s72, s72, 24576
  s_cmp_eq_u32 s72, 98304
  s_cselect_b32 s72, 0, s72
  s_add_u32 s73, s73, 1
  s_cmp_lt_u32 s73, 6
  s_cbranch_scc1 L_ll_3
  s_cmp_eq_u32 s42, 8
  s_cbranch_scc1 L_w8_4
  s_mov_b32 s73, 0
L_ll_5:
  s_waitcnt vmcnt(6)
  s_barrier
  s_lshl_b32 s74, s71, 7
  s_add_u32 s74, s74, s58
  s_add_u32 s75, s60, s72
  s_add_u32 m0, s75, 0
  s_nop 0
  buffer_load_dwordx4 v40, s[24:27], s74 offen lds
  s_add_u32 m0, s75, 1024
  s_nop 0
  buffer_load_dwordx4 v41, s[24:27], s74 offen lds
  s_add_u32 m0, s75, 2048
  s_nop 0
  buffer_load_dwordx4 v42, s[24:27], s74 offen lds
  s_add_u32 m0, s75, 3072
  s_nop 0
  buffer_load_dwordx4 v43, s[24:27], s74 offen lds
  s_lshl_b32 s74, s71, 17
  s_add_u32 s74, s74, s59
  s_add_u32 s75, s61, s72
  s_add_u32 m0, s75, 16384
  s_nop 0
  buffer_load_dwordx4 v44, s[28:31], s74 offen lds
  s_add_u32 m0, s75, 17408
  s_nop 0
  buffer_load_dwordx4 v45, s[28:31], s74 offen lds
  s_add_u32 s71, s71, 1
  s_and_b32 s71, s71, 15
  s_add_u32 s72, s72, 24576
  s_cmp_eq_u32 s72, 98304
  s_cselect_b32 s72, 0, s72
  s_add_u32 s73, s73, 1
  s_cmp_lt_u32 s73, 6
  s_cbranch_scc1 L_ll_5
  s_waitcnt vmcnt(6)
  s_barrier
  s_waitcnt vmcnt(0)
  s_barrier
  s_mov_b32 s20, s100
  s_mov_b32 s21, s101
  s_mov_b32 s22, 4194304
  s_mov_b32 s23, 0x20000
  s_sub_u32 s53, s42, 9
  s_lshl_b32 s53, s53, 5
  s_add_u32 s53, s53, s66
  s_cmp_lt_u32 s53, 72
  s_cselect_b64 s[16:17], -1, 0
  s_mul_i32 s44, s65, 360
  s_add_u32 s44, s44, s53
  s_add_u32 s45, s44, 96
  s_add_u32 s46, s44, 192
  s_add_u32 s47, s44, 288
L_b0_6:
  s_barrier
  v_mov_b32 v1, 163824
  ds_read_b32 v2, v1
  s_waitcnt lgkmcnt(0)
  v_readfirstlane_b32 s3, v2
  s_cmp_eq_u32 s3, 0
  s_cbranch_scc1 L_b1_7
  s_barrier
  s_mov_b32 s49, 0
L_fbb_8:
  s_barrier
  s_barrier
  s_add_u32 s49, s49, 1
  s_cmp_lt_u32 s49, 256
  s_cbranch_scc1 L_fbb_8
  s_barrier
  s_branch L_b0_6
L_b1_7:
  v_mov_b32 v64, 0
  v_mov_b32 v65, 0
  v_mov_b32 v66, 0
  v_mov_b32 v67, 0
  v_mov_b32 v68, 0
  v_mov_b32 v69, 0
  v_mov_b32 v70, 0
  v_mov_b32 v71, 0
  v_mov_b32 v72, 0
  v_mov_b32 v73, 0
  v_mov_b32 v74, 0
  v_mov_b32 v75, 0
  v_mov_b32 v76, 0
  v_mov_b32 v77, 0
  v_mov_b32 v78, 0
  v_mov_b32 v79, 0
  s_mov_b32 s53, 0x33333334
  s_mul_hi_u32 s54, s44, s53
  s_mul_i32 s53, s54, 5
  s_sub_u32 s53, s44, s53
  s_lshl_b32 s53, s53, 6
  v_add_u32 v10, s53, v4
  s_mul_i32 s44, s54, 640
  s_add_u32 s44, s44, 10485760
  s_mov_b32 s55, 1.0
  s_and_b32 s53, s54, 511
  s_cmp_eq_u32 s53, 0
  s_cselect_b32 s55, 0.5, s55
  s_cmp_gt_u32 s54, 512
  s_cselect_b32 s55, 0, s55
  s_cselect_b32 s54, 0, s54
  s_lshl_b32 s72, s54, 11
  s_sub_u32 s73, 2048, s54
  s_and_b32 s73, s73, 2047
  s_lshl_b32 s73, s73, 11
  s_sub_u32 s74, 1024, s54
  s_lshl_b32 s74, s74, 11
  s_add_u32 s75, 1024, s54
  s_lshl_b32 s75, s75, 11
  v_lshlrev_b32 v128, 1, v10
  v_sub_u32 v6, 2048, v128
  v_and_b32 v6, 2047, v6
  v_sub_u32 v7, 1024, v128
  buffer_load_short_d16_hi v64, v128, s[20:23], s72 offen
  buffer_load_short_d16_hi v66, v6, s[20:23], s72 offen
  buffer_load_short_d16_hi v65, v7, s[20:23], s72 offen
  buffer_load_short_d16_hi v67, v128, s[20:23], s72 offen offset:1024
  buffer_load_short_d16_hi v68, v128, s[20:23], s73 offen
  buffer_load_short_d16_hi v70, v6, s[20:23], s73 offen
  buffer_load_short_d16_hi v69, v7, s[20:23], s73 offen
  buffer_load_short_d16_hi v71, v128, s[20:23], s73 offen offset:1024
  buffer_load_short_d16_hi v72, v128, s[20:23], s74 offen
  buffer_load_short_d16_hi v74, v6, s[20:23], s74 offen
  buffer_load_short_d16_hi v73, v7, s[20:23], s74 offen
  buffer_load_short_d16_hi v75, v128, s[20:23], s74 offen offset:1024
  buffer_load_short_d16_hi v76, v128, s[20:23], s75 offen
  buffer_load_short_d16_hi v78, v6, s[20:23], s75 offen
  buffer_load_short_d16_hi v77, v7, s[20:23], s75 offen
  buffer_load_short_d16_hi v79, v128, s[20:23], s75 offen offset:1024
  v_mov_b32 v152, s55
  v_and_b32 v1, 255, v10
  v_cmp_eq_u32 vcc, 0, v1
  v_mul_f32 v1, 0.5, v152
  s_nop 1
  v_cndmask_b32 v152, v152, v1, vcc
  v_cmp_lt_u32 vcc, 256, v10
  s_nop 1
  v_cndmask_b32 v152, v152, 0, vcc
  s_barrier
  v_mov_b32 v80, 0
  v_mov_b32 v81, 0
  v_mov_b32 v82, 0
  v_mov_b32 v83, 0
  v_mov_b32 v84, 0
  v_mov_b32 v85, 0
  v_mov_b32 v86, 0
  v_mov_b32 v87, 0
  v_mov_b32 v88, 0
  v_mov_b32 v89, 0
  v_mov_b32 v90, 0
  v_mov_b32 v91, 0
  v_mov_b32 v92, 0
  v_mov_b32 v93, 0
  v_mov_b32 v94, 0
  v_mov_b32 v95, 0
  s_mov_b32 s53, 0x33333334
  s_mul_hi_u32 s54, s45, s53
  s_mul_i32 s53, s54, 5
  s_sub_u32 s53, s45, s53
  s_lshl_b32 s53, s53, 6
  v_add_u32 v10, s53, v4
  s_mul_i32 s45, s54, 640
  s_add_u32 s45, s45, 10485760
  s_mov_b32 s55, 1.0
  s_and_b32 s53, s54, 511
  s_cmp_eq_u32 s53, 0
  s_cselect_b32 s55, 0.5, s55
  s_cmp_gt_u32 s54, 512
  s_cselect_b32 s55, 0, s55
  s_cselect_b32 s54, 0, s54
  s_lshl_b32 s72, s54, 11
  s_sub_u32 s73, 2048, s54
  s_and_b32 s73, s73, 2047
  s_lshl_b32 s73, s73, 11
  s_sub_u32 s74, 1024, s54
  s_lshl_b32 s74, s74, 11
  s_add_u32 s75, 1024, s54
  s_lshl_b32 s75, s75, 11
  v_lshlrev_b32 v129, 1, v10
  v_sub_u32 v6, 2048, v129
  v_and_b32 v6, 2047, v6
  v_sub_u32 v7, 1024, v129
  buffer_load_short_d16_hi v80, v129, s[20:23], s72 offen
  buffer_load_short_d16_hi v82, v6, s[20:23], s72 offen
  buffer_load_short_d16_hi v81, v7, s[20:23], s72 offen
  buffer_load_short_d16_hi v83, v129, s[20:23], s72 offen offset:1024
  buffer_load_short_d16_hi v84, v129, s[20:23], s73 offen
  buffer_load_short_d16_hi v86, v6, s[20:23], s73 offen
  buffer_load_short_d16_hi v85, v7, s[20:23], s73 offen
  buffer_load_short_d16_hi v87, v129, s[20:23], s73 offen offset:1024
  buffer_load_short_d16_hi v88, v129, s[20:23], s74 offen
  buffer_load_short_d16_hi v90, v6, s[20:23], s74 offen
  buffer_load_short_d16_hi v89, v7, s[20:23], s74 offen
  buffer_load_short_d16_hi v91, v129, s[20:23], s74 offen offset:1024
  buffer_load_short_d16_hi v92, v129, s[20:23], s75 offen
  buffer_load_short_d16_hi v94, v6, s[20:23], s75 offen
  buffer_load_short_d16_hi v93, v7, s[20:23], s75 offen
  buffer_load_short_d16_hi v95, v129, s[20:23], s75 offen offset:1024
  v_mov_b32 v154, s55
  v_and_b32 v1, 255, v10
  v_cmp_eq_u32 vcc, 0, v1
  v_mul_f32 v1, 0.5, v154
  s_nop 1
  v_cndmask_b32 v154, v154, v1, vcc
  v_cmp_lt_u32 vcc, 256, v10
  s_nop 1
  v_cndmask_b32 v154, v154, 0, vcc
  s_barrier
  v_mov_b32 v96, 0
  v_mov_b32 v97, 0
  v_mov_b32 v98, 0
  v_mov_b32 v99, 0
  v_mov_b32 v100, 0
  v_mov_b32 v101, 0
  v_mov_b32 v102, 0
  v_mov_b32 v103, 0
  v_mov_b32 v104, 0
  v_mov_b32 v105, 0
  v_mov_b32 v106, 0
  v_mov_b32 v107, 0
  v_mov_b32 v108, 0
  v_mov_b32 v109, 0
  v_mov_b32 v110, 0
  v_mov_b32 v111, 0
  s_mov_b32 s53, 0x33333334
  s_mul_hi_u32 s54, s46, s53
  s_mul_i32 s53, s54, 5
  s_sub_u32 s53, s46, s53
  s_lshl_b32 s53, s53, 6
  v_add_u32 v10, s53, v4
  s_mul_i32 s46, s54, 640
  s_add_u32 s46, s46, 10485760
  s_mov_b32 s55, 1.0
  s_and_b32 s53, s54, 511
  s_cmp_eq_u32 s53, 0
  s_cselect_b32 s55, 0.5, s55
  s_cmp_gt_u32 s54, 512
  s_cselect_b32 s55, 0, s55
  s_cselect_b32 s54, 0, s54
  s_lshl_b32 s72, s54, 11
  s_sub_u32 s73, 2048, s54
  s_and_b32 s73, s73, 2047
  s_lshl_b32 s73, s73, 11
  s_sub_u32 s74, 1024, s54
  s_lshl_b32 s74, s74, 11
  s_add_u32 s75, 1024, s54
  s_lshl_b32 s75, s75, 11
  v_lshlrev_b32 v130, 1, v10
  v_sub_u32 v6, 2048, v130
  v_and_b32 v6, 2047, v6
  v_sub_u32 v7, 1024, v130
  buffer_load_short_d16_hi v96, v130, s[20:23], s72 offen
  buffer_load_short_d16_hi v98, v6, s[20:23], s72 offen
  buffer_load_short_d16_hi v97, v7, s[20:23], s72 offen
  buffer_load_short_d16_hi v99, v130, s[20:23], s72 offen offset:1024
  buffer_load_short_d16_hi v100, v130, s[20:23], s73 offen
  buffer_load_short_d16_hi v102, v6, s[20:23], s73 offen
  buffer_load_short_d16_hi v101, v7, s[20:23], s73 offen
  buffer_load_short_d16_hi v103, v130, s[20:23], s73 offen offset:1024
  buffer_load_short_d16_hi v104, v130, s[20:23], s74 offen
  buffer_load_short_d16_hi v106, v6, s[20:23], s74 offen
  buffer_load_short_d16_hi v105, v7, s[20:23], s74 offen
  buffer_load_short_d16_hi v107, v130, s[20:23], s74 offen offset:1024
  buffer_load_short_d16_hi v108, v130, s[20:23], s75 offen
  buffer_load_short_d16_hi v110, v6, s[20:23], s75 offen
  buffer_load_short_d16_hi v109, v7, s[20:23], s75 offen
  buffer_load_short_d16_hi v111, v130, s[20:23], s75 offen offset:1024
  v_mov_b32 v156, s55
  v_and_b32 v1, 255, v10
  v_cmp_eq_u32 vcc, 0, v1
  v_mul_f32 v1, 0.5, v156
  s_nop 1
  v_cndmask_b32 v156, v156, v1, vcc
  v_cmp_lt_u32 vcc, 256, v10
  s_nop 1
  v_cndmask_b32 v156, v156, 0, vcc
  s_waitcnt vmcnt(32)
  v_pk_add_f32 v[2:3], v[64:65], v[68:69]
  v_pk_add_f32 v[6:7], v[64:65], v[68:69] neg_lo:[0,1] neg_hi:[0,1]
  v_pk_add_f32 v[8:9], v[72:73], v[76:77]
  v_pk_add_f32 v[10:11], v[72:73], v[76:77] neg_lo:[0,1] neg_hi:[0,1]
  v_pk_add_f32 v[64:65], v[2:3], v[8:9]
  v_pk_add_f32 v[68:69], v[2:3], v[8:9] neg_lo:[0,1] neg_hi:[0,1]
  v_pk_add_f32 v[72:73], v[6:7], v[10:11] neg_lo:[0,1] neg_hi:[0,1]
  v_pk_add_f32 v[76:77], v[6:7], v[10:11]
  v_pk_add_f32 v[2:3], v[66:67], v[70:71]
  v_pk_add_f32 v[6:7], v[66:67], v[70:71] neg_lo:[0,1] neg_hi:[0,1]
  v_pk_add_f32 v[8:9], v[74:75], v[78:79]
  v_pk_add_f32 v[10:11], v[74:75], v[78:79] neg_lo:[0,1] neg_hi:[0,1]
  v_pk_add_f32 v[66:67], v[2:3], v[8:9]
  v_pk_add_f32 v[70:71], v[2:3], v[8:9] neg_lo:[0,1] neg_hi:[0,1]
  v_pk_add_f32 v[74:75], v[6:7], v[10:11] neg_lo:[0,1] neg_hi:[0,1]
  v_pk_add_f32 v[78:79], v[6:7], v[10:11]
  v_pk_add_f32 v[2:3], v[64:65], v[66:67]
  v_pk_add_f32 v[6:7], v[2:3], v[2:3] op_sel:[0,1] op_sel_hi:[0,1] neg_hi:[0,1]
  v_pk_mul_f32 v[6:7], v[6:7], v[152:153] op_sel_hi:[1,0]
  v_cvt_pk_bf16_f32 v136, v6, v7
  s_add_u32 s53, s44, 0
  s_add_u32 s54, s44, 368640
  buffer_store_short v136, v128, s[32:35], s53 offen sc0 sc1
  buffer_store_short_d16_hi v136, v128, s[32:35], s54 offen sc0 sc1
  v_pk_add_f32 v[2:3], v[68:69], v[70:71]
  v_pk_add_f32 v[6:7], v[2:3], v[2:3] op_sel:[0,1] op_sel_hi:[0,1] neg_hi:[0,1]
  v_pk_mul_f32 v[6:7], v[6:7], v[152:153] op_sel_hi:[1,0]
  v_cvt_pk_bf16_f32 v137, v6, v7
  s_add_u32 s53, s44, 737280
  s_add_u32 s54, s44, 1105920
  buffer_store_short v137, v128, s[32:35], s53 offen sc0 sc1
  buffer_store_short_d16_hi v137, v128, s[32:35], s54 offen sc0 sc1
  v_pk_add_f32 v[2:3], v[72:73], v[74:75] neg_lo:[0,1] neg_hi:[0,1]
  v_pk_add_f32 v[6:7], v[2:3], v[2:3] op_sel:[0,1] op_sel_hi:[0,1] neg_lo:[0,1]
  v_pk_mul_f32 v[6:7], v[6:7], v[152:153] op_sel_hi:[1,0]
  v_cvt_pk_bf16_f32 v138, v6, v7
  s_add_u32 s53, s44, 1474560
  s_add_u32 s54, s44, 1843200
  buffer_store_short v138, v128, s[32:35], s53 offen sc0 sc1
  buffer_store_short_d16_hi v138, v128, s[32:35], s54 offen sc0 sc1
  v_pk_add_f32 v[2:3], v[76:77], v[78:79] neg_lo:[0,1] neg_hi:[0,1]
  v_pk_add_f32 v[6:7], v[2:3], v[2:3] op_sel:[0,1] op_sel_hi:[0,1] neg_lo:[0,1]
  v_pk_mul_f32 v[6:7], v[6:7], v[152:153] op_sel_hi:[1,0]
  v_cvt_pk_bf16_f32 v139, v6, v7
  s_add_u32 s53, s44, 2211840
  s_add_u32 s54, s44, 2580480
  buffer_store_short v139, v128, s[32:35], s53 offen sc0 sc1
  buffer_store_short_d16_hi v139, v128, s[32:35], s54 offen sc0 sc1
  s_barrier
  v_mov_b32 v112, 0
  v_mov_b32 v113, 0
  v_mov_b32 v114, 0
  v_mov_b32 v115, 0
  v_mov_b32 v116, 0
  v_mov_b32 v117, 0
  v_mov_b32 v118, 0
  v_mov_b32 v119, 0
  v_mov_b32 v120, 0
  v_mov_b32 v121, 0
  v_mov_b32 v122, 0
  v_mov_b32 v123, 0
  v_mov_b32 v124, 0
  v_mov_b32 v125, 0
  v_mov_b32 v126, 0
  v_mov_b32 v127, 0
  s_mov_b32 s53, 0x33333334
  s_mul_hi_u32 s54, s47, s53
  s_mul_i32 s53, s54, 5
  s_sub_u32 s53, s47, s53
  s_lshl_b32 s53, s53, 6
  v_add_u32 v10, s53, v4
  s_mul_i32 s47, s54, 640
  s_add_u32 s47, s47, 10485760
  s_mov_b32 s55, 1.0
  s_and_b32 s53, s54, 511
  s_cmp_eq_u32 s53, 0
  s_cselect_b32 s55, 0.5, s55
  s_cmp_gt_u32 s54, 512
  s_cselect_b32 s55, 0, s55
  s_cselect_b32 s54, 0, s54
  s_lshl_b32 s72, s54, 11
  s_sub_u32 s73, 2048, s54
  s_and_b32 s73, s73, 2047
  s_lshl_b32 s73, s73, 11
  s_sub_u32 s74, 1024, s54
  s_lshl_b32 s74, s74, 11
  s_add_u32 s75, 1024, s54
  s_lshl_b32 s75, s75, 11
  v_lshlrev_b32 v131, 1, v10
  v_sub_u32 v6, 2048, v131
  v_and_b32 v6, 2047, v6
  v_sub_u32 v7, 1024, v131
  s_mov_b64 exec, s[16:17]
  buffer_load_short_d16_hi v112, v131, s[20:23], s72 offen
  buffer_load_short_d16_hi v114, v6, s[20:23], s72 offen
  buffer_load_short_d16_hi v113, v7, s[20:23], s72 offen
  buffer_load_short_d16_hi v115, v131, s[20:23], s72 offen offset:1024
  buffer_load_short_d16_hi v116, v131, s[20:23], s73 offen
  buffer_load_short_d16_hi v118, v6, s[20:23], s73 offen
  buffer_load_short_d16_hi v117, v7, s[20:23], s73 offen
  buffer_load_short_d16_hi v119, v131, s[20:23], s73 offen offset:1024
  buffer_load_short_d16_hi v120, v131, s[20:23], s74 offen
  buffer_load_short_d16_hi v122, v6, s[20:23], s74 offen
  buffer_load_short_d16_hi v121, v7, s[20:23], s74 offen
  buffer_load_short_d16_hi v123, v131, s[20:23], s74 offen offset:1024
  buffer_load_short_d16_hi v124, v131, s[20:23], s75 offen
  buffer_load_short_d16_hi v126, v6, s[20:23], s75 offen
  buffer_load_short_d16_hi v125, v7, s[20:23], s75 offen
  buffer_load_short_d16_hi v127, v131, s[20:23], s75 offen offset:1024
  s_mov_b64 exec, -1
  v_mov_b32 v158, s55
  v_and_b32 v1, 255, v10
  v_cmp_eq_u32 vcc, 0, v1
  v_mul_f32 v1, 0.5, v158
  s_nop 1
  v_cndmask_b32 v158, v158, v1, vcc
  v_cmp_lt_u32 vcc, 256, v10
  s_nop 1
  v_cndmask_b32 v158, v158, 0, vcc
  s_waitcnt vmcnt(40)
  v_pk_add_f32 v[2:3], v[80:81], v[84:85]
  v_pk_add_f32 v[6:7], v[80:81], v[84:85] neg_lo:[0,1] neg_hi:[0,1]
  v_pk_add_f32 v[8:9], v[88:89], v[92:93]
  v_pk_add_f32 v[10:11], v[88:89], v[92:93] neg_lo:[0,1] neg_hi:[0,1]
  v_pk_add_f32 v[80:81], v[2:3], v[8:9]
  v_pk_add_f32 v[84:85], v[2:3], v[8:9] neg_lo:[0,1] neg_hi:[0,1]
  v_pk_add_f32 v[88:89], v[6:7], v[10:11] neg_lo:[0,1] neg_hi:[0,1]
  v_pk_add_f32 v[92:93], v[6:7], v[10:11]
  v_pk_add_f32 v[2:3], v[82:83], v[86:87]
  v_pk_add_f32 v[6:7], v[82:83], v[86:87] neg_lo:[0,1] neg_hi:[0,1]
  v_pk_add_f32 v[8:9], v[90:91], v[94:95]
  v_pk_add_f32 v[10:11], v[90:91], v[94:95] neg_lo:[0,1] neg_hi:[0,1]
  v_pk_add_f32 v[82:83], v[2:3], v[8:9]
  v_pk_add_f32 v[86:87], v[2:3], v[8:9] neg_lo:[0,1] neg_hi:[0,1]
  v_pk_add_f32 v[90:91], v[6:7], v[10:11] neg_lo:[0,1] neg_hi:[0,1]
  v_pk_add_f32 v[94:95], v[6:7], v[10:11]
  v_pk_add_f32 v[2:3], v[80:81], v[82:83]
  v_pk_add_f32 v[6:7], v[2:3], v[2:3] op_sel:[0,1] op_sel_hi:[0,1] neg_hi:[0,1]
  v_pk_mul_f32 v[6:7], v[6:7], v[154:155] op_sel_hi:[1,0]
  v_cvt_pk_bf16_f32 v140, v6, v7
  s_add_u32 s53, s45, 0
  s_add_u32 s54, s45, 368640
  buffer_store_short v140, v129, s[32:35], s53 offen sc0 sc1
  buffer_store_short_d16_hi v140, v129, s[32:35], s54 offen sc0 sc1
  v_pk_add_f32 v[2:3], v[84:85], v[86:87]
  v_pk_add_f32 v[6:7], v[2:3], v[2:3] op_sel:[0,1] op_sel_hi:[0,1] neg_hi:[0,1]
  v_pk_mul_f32 v[6:7], v[6:7], v[154:155] op_sel_hi:[1,0]
  v_cvt_pk_bf16_f32 v141, v6, v7
  s_add_u32 s53, s45, 737280
  s_add_u32 s54, s45, 1105920
  buffer_store_short v141, v129, s[32:35], s53 offen sc0 sc1
  buffer_store_short_d16_hi v141, v129, s[32:35], s54 offen sc0 sc1
  v_pk_add_f32 v[2:3], v[88:89], v[90:91] neg_lo:[0,1] neg_hi:[0,1]
  v_pk_add_f32 v[6:7], v[2:3], v[2:3] op_sel:[0,1] op_sel_hi:[0,1] neg_lo:[0,1]
  v_pk_mul_f32 v[6:7], v[6:7], v[154:155] op_sel_hi:[1,0]
  v_cvt_pk_bf16_f32 v142, v6, v7
  s_add_u32 s53, s45, 1474560
  s_add_u32 s54, s45, 1843200
  buffer_store_short v142, v129, s[32:35], s53 offen sc0 sc1
  buffer_store_short_d16_hi v142, v129, s[32:35], s54 offen sc0 sc1
  v_pk_add_f32 v[2:3], v[92:93], v[94:95] neg_lo:[0,1] neg_hi:[0,1]
  v_pk_add_f32 v[6:7], v[2:3], v[2:3] op_sel:[0,1] op_sel_hi:[0,1] neg_lo:[0,1]
  v_pk_mul_f32 v[6:7], v[6:7], v[154:155] op_sel_hi:[1,0]
  v_cvt_pk_bf16_f32 v143, v6, v7
  s_add_u32 s53, s45, 2211840
  s_add_u32 s54, s45, 2580480
  buffer_store_short v143, v129, s[32:35], s53 offen sc0 sc1
  buffer_store_short_d16_hi v143, v129, s[32:35], s54 offen sc0 sc1
  s_barrier
  s_waitcnt vmcnt(32)
  v_pk_add_f32 v[2:3], v[96:97], v[100:101]
  v_pk_add_f32 v[6:7], v[96:97], v[100:101] neg_lo:[0,1] neg_hi:[0,1]
  v_pk_add_f32 v[8:9], v[104:105], v[108:109]
  v_pk_add_f32 v[10:11], v[104:105], v[108:109] neg_lo:[0,1] neg_hi:[0,1]
  v_pk_add_f32 v[96:97], v[2:3], v[8:9]
  v_pk_add_f32 v[100:101], v[2:3], v[8:9] neg_lo:[0,1] neg_hi:[0,1]
  v_pk_add_f32 v[104:105], v[6:7], v[10:11] neg_lo:[0,1] neg_hi:[0,1]
  v_pk_add_f32 v[108:109], v[6:7], v[10:11]
  v_pk_add_f32 v[2:3], v[98:99], v[102:103]
  v_pk_add_f32 v[6:7], v[98:99], v[102:103] neg_lo:[0,1] neg_hi:[0,1]
  v_pk_add_f32 v[8:9], v[106:107], v[110:111]
  v_pk_add_f32 v[10:11], v[106:107], v[110:111] neg_lo:[0,1] neg_hi:[0,1]
  v_pk_add_f32 v[98:99], v[2:3], v[8:9]
  v_pk_add_f32 v[102:103], v[2:3], v[8:9] neg_lo:[0,1] neg_hi:[0,1]
  v_pk_add_f32 v[106:107], v[6:7], v[10:11] neg_lo:[0,1] neg_hi:[0,1]
  v_pk_add_f32 v[110:111], v[6:7], v[10:11]
  v_pk_add_f32 v[2:3], v[96:97], v[98:99]
  v_pk_add_f32 v[6:7], v[2:3], v[2:3] op_sel:[0,1] op_sel_hi:[0,1] neg_hi:[0,1]
  v_pk_mul_f32 v[6:7], v[6:7], v[156:157] op_sel_hi:[1,0]
  v_cvt_pk_bf16_f32 v144, v6, v7
  s_add_u32 s53, s46, 0
  s_add_u32 s54, s46, 368640
  buffer_store_short v144, v130, s[32:35], s53 offen sc0 sc1
  buffer_store_short_d16_hi v144, v130, s[32:35], s54 offen sc0 sc1
  v_pk_add_f32 v[2:3], v[100:101], v[102:103]
  v_pk_add_f32 v[6:7], v[2:3], v[2:3] op_sel:[0,1] op_sel_hi:[0,1] neg_hi:[0,1]
  v_pk_mul_f32 v[6:7], v[6:7], v[156:157] op_sel_hi:[1,0]
  v_cvt_pk_bf16_f32 v145, v6, v7
  s_add_u32 s53, s46, 737280
  s_add_u32 s54, s46, 1105920
  buffer_store_short v145, v130, s[32:35], s53 offen sc0 sc1
  buffer_store_short_d16_hi v145, v130, s[32:35], s54 offen sc0 sc1
  v_pk_add_f32 v[2:3], v[104:105], v[106:107] neg_lo:[0,1] neg_hi:[0,1]
  v_pk_add_f32 v[6:7], v[2:3], v[2:3] op_sel:[0,1] op_sel_hi:[0,1] neg_lo:[0,1]
  v_pk_mul_f32 v[6:7], v[6:7], v[156:157] op_sel_hi:[1,0]
  v_cvt_pk_bf16_f32 v146, v6, v7
  s_add_u32 s53, s46, 1474560
  s_add_u32 s54, s46, 1843200
  buffer_store_short v146, v130, s[32:35], s53 offen sc0 sc1
  buffer_store_short_d16_hi v146, v130, s[32:35], s54 offen sc0 sc1
  v_pk_add_f32 v[2:3], v[108:109], v[110:111] neg_lo:[0,1] neg_hi:[0,1]
  v_pk_add_f32 v[6:7], v[2:3], v[2:3] op_sel:[0,1] op_sel_hi:[0,1] neg_lo:[0,1]
  v_pk_mul_f32 v[6:7], v[6:7], v[156:157] op_sel_hi:[1,0]
  v_cvt_pk_bf16_f32 v147, v6, v7
  s_add_u32 s53, s46, 2211840
  s_add_u32 s54, s46, 2580480
  buffer_store_short v147, v130, s[32:35], s53 offen sc0 sc1
  buffer_store_short_d16_hi v147, v130, s[32:35], s54 offen sc0 sc1
  s_barrier
  s_waitcnt vmcnt(16)
  s_mov_b64 exec, s[16:17]
  v_pk_add_f32 v[2:3], v[112:113], v[116:117]
  v_pk_add_f32 v[6:7], v[112:113], v[116:117] neg_lo:[0,1] neg_hi:[0,1]
  v_pk_add_f32 v[8:9], v[120:121], v[124:125]
  v_pk_add_f32 v[10:11], v[120:121], v[124:125] neg_lo:[0,1] neg_hi:[0,1]
  v_pk_add_f32 v[112:113], v[2:3], v[8:9]
  v_pk_add_f32 v[116:117], v[2:3], v[8:9] neg_lo:[0,1] neg_hi:[0,1]
  v_pk_add_f32 v[120:121], v[6:7], v[10:11] neg_lo:[0,1] neg_hi:[0,1]
  v_pk_add_f32 v[124:125], v[6:7], v[10:11]
  v_pk_add_f32 v[2:3], v[114:115], v[118:119]
  v_pk_add_f32 v[6:7], v[114:115], v[118:119] neg_lo:[0,1] neg_hi:[0,1]
  v_pk_add_f32 v[8:9], v[122:123], v[126:127]
  v_pk_add_f32 v[10:11], v[122:123], v[126:127] neg_lo:[0,1] neg_hi:[0,1]
  v_pk_add_f32 v[114:115], v[2:3], v[8:9]
  v_pk_add_f32 v[118:119], v[2:3], v[8:9] neg_lo:[0,1] neg_hi:[0,1]
  v_pk_add_f32 v[122:123], v[6:7], v[10:11] neg_lo:[0,1] neg_hi:[0,1]
  v_pk_add_f32 v[126:127], v[6:7], v[10:11]
  v_pk_add_f32 v[2:3], v[112:113], v[114:115]
  v_pk_add_f32 v[6:7], v[2:3], v[2:3] op_sel:[0,1] op_sel_hi:[0,1] neg_hi:[0,1]
  v_pk_mul_f32 v[6:7], v[6:7], v[158:159] op_sel_hi:[1,0]
  v_cvt_pk_bf16_f32 v148, v6, v7
  s_add_u32 s53, s47, 0
  s_add_u32 s54, s47, 368640
  buffer_store_short v148, v131, s[32:35], s53 offen sc0 sc1
  buffer_store_short_d16_hi v148, v131, s[32:35], s54 offen sc0 sc1
  v_pk_add_f32 v[2:3], v[116:117], v[118:119]
  v_pk_add_f32 v[6:7], v[2:3], v[2:3] op_sel:[0,1] op_sel_hi:[0,1] neg_hi:[0,1]
  v_pk_mul_f32 v[6:7], v[6:7], v[158:159] op_sel_hi:[1,0]
  v_cvt_pk_bf16_f32 v149, v6, v7
  s_add_u32 s53, s47, 737280
  s_add_u32 s54, s47, 1105920
  buffer_store_short v149, v131, s[32:35], s53 offen sc0 sc1
  buffer_store_short_d16_hi v149, v131, s[32:35], s54 offen sc0 sc1
  v_pk_add_f32 v[2:3], v[120:121], v[122:123] neg_lo:[0,1] neg_hi:[0,1]
  v_pk_add_f32 v[6:7], v[2:3], v[2:3] op_sel:[0,1] op_sel_hi:[0,1] neg_lo:[0,1]
  v_pk_mul_f32 v[6:7], v[6:7], v[158:159] op_sel_hi:[1,0]
  v_cvt_pk_bf16_f32 v150, v6, v7
  s_add_u32 s53, s47, 1474560
  s_add_u32 s54, s47, 1843200
  buffer_store_short v150, v131, s[32:35], s53 offen sc0 sc1
  buffer_store_short_d16_hi v150, v131, s[32:35], s54 offen sc0 sc1
  v_pk_add_f32 v[2:3], v[124:125], v[126:127] neg_lo:[0,1] neg_hi:[0,1]
  v_pk_add_f32 v[6:7], v[2:3], v[2:3] op_sel:[0,1] op_sel_hi:[0,1] neg_lo:[0,1]
  v_pk_mul_f32 v[6:7], v[6:7], v[158:159] op_sel_hi:[1,0]
  v_cvt_pk_bf16_f32 v151, v6, v7
  s_add_u32 s53, s47, 2211840
  s_add_u32 s54, s47, 2580480
  buffer_store_short v151, v131, s[32:35], s53 offen sc0 sc1
  buffer_store_short_d16_hi v151, v131, s[32:35], s54 offen sc0 sc1
  s_mov_b64 exec, -1
  v_mov_b32 v57, 0
  global_load_dword v56, v57, s[62:63] sc0 sc1
  s_barrier
  s_waitcnt vmcnt(0)
  s_barrier
  s_cmp_lg_u32 s42, 9
  s_cbranch_scc1 L_s1w_9
  v_readfirstlane_b32 s3, v56
  s_cmp_lg_u32 s3, 1
  s_cbranch_scc1 L_s1w_9
  s_and_b32 s3, s2, 15
  s_lshl_b32 s3, s3, 7
  s_lshr_b32 s64, s2, 4
  s_add_u32 s3, s3, s64
  v_mov_b32 v1, s3
  v_mov_b32 v2, 1
  s_mov_b64 exec, 1
  buffer_store_byte v2, v1, s[32:35], 0 offen offset:2048 sc0 sc1
  s_mov_b64 exec, -1
L_s1w_9:
  s_cmp_ge_u32 s66, 27
  s_cbranch_scc1 L_end_1
  s_sub_u32 s54, s42, 9
  v_bfe_u32 v1, v4, 1, 3
  v_lshrrev_b32 v2, 5, v4
  v_xor_b32 v1, v1, v2
  v_lshlrev_b32 v1, 4, v1
  v_and_b32 v2, 31, v4
  v_lshl_add_u32 v6, v2, 7, v1
  s_lshl_b32 s56, s54, 12
  s_add_u32 s56, s56, 57344
  v_xor_b32 v7, 0, v6
  v_add_u32 v12, 49152, v7
  v_add_u32 v16, s56, v7
  v_xor_b32 v7, 32, v6
  v_add_u32 v13, 49152, v7
  v_add_u32 v17, s56, v7
  v_xor_b32 v7, 64, v6
  v_add_u32 v14, 49152, v7
  v_add_u32 v18, s56, v7
  v_xor_b32 v7, 96, v6
  v_add_u32 v15, 49152, v7
  v_add_u32 v19, s56, v7
  s_mul_i32 s55, s50, 331776
  s_mul_i32 s56, s52, 3
  s_add_u32 s56, s56, s54
  s_mul_i32 s56, s56, 36864
  s_add_u32 s55, s55, s56
  s_lshl_b32 s56, s51, 12
  s_add_u32 s55, s55, s56
  s_add_u32 s55, s55, 14680064
  s_barrier
  s_barrier
  s_barrier
  s_barrier
  s_barrier
  ds_read_b128 v[64:67], v16
  ds_read_b128 v[68:71], v12
  ds_read_b128 v[72:75], v12 offset:4096
  ds_read_b128 v[76:79], v17
  ds_read_b128 v[80:83], v13
  ds_read_b128 v[84:87], v13 offset:4096
  ds_read_b128 v[88:91], v18
  ds_read_b128 v[92:95], v14
  ds_read_b128 v[96:99], v14 offset:4096
  ds_read_b128 v[100:103], v19
  ds_read_b128 v[104:107], v15
  ds_read_b128 v[108:111], v15 offset:4096
  s_waitcnt lgkmcnt(9)
  v_mfma_f32_32x32x16_bf16 v[112:127], v[68:71], v[64:67], 0
  v_mfma_f32_32x32x16_bf16 v[128:143], v[72:75], v[64:67], 0
  s_waitcnt lgkmcnt(6)
  v_mfma_f32_32x32x16_bf16 v[112:127], v[80:83], v[76:79], v[112:127]
  v_mfma_f32_32x32x16_bf16 v[128:143], v[84:87], v[76:79], v[128:143]
  s_waitcnt lgkmcnt(3)
  v_mfma_f32_32x32x16_bf16 v[112:127], v[92:95], v[88:91], v[112:127]
  v_mfma_f32_32x32x16_bf16 v[128:143], v[96:99], v[88:91], v[128:143]
  s_waitcnt lgkmcnt(0)
  v_mfma_f32_32x32x16_bf16 v[112:127], v[104:107], v[100:103], v[112:127]
  v_mfma_f32_32x32x16_bf16 v[128:143], v[108:111], v[100:103], v[128:143]
  v_add_u32 v12, 20480, v12
  v_add_u32 v13, 20480, v13
  v_add_u32 v14, 20480, v14
  v_add_u32 v15, 20480, v15
  v_add_u32 v16, 20480, v16
  v_add_u32 v17, 20480, v17
  v_add_u32 v18, 20480, v18
  v_add_u32 v19, 20480, v19
  s_barrier
  ds_read_b128 v[64:67], v16
  ds_read_b128 v[68:71], v12
  ds_read_b128 v[72:75], v12 offset:4096
  ds_read_b128 v[76:79], v17
  ds_read_b128 v[80:83], v13
  ds_read_b128 v[84:87], v13 offset:4096
  ds_read_b128 v[88:91], v18
  ds_read_b128 v[92:95], v14
  ds_read_b128 v[96:99], v14 offset:4096
  ds_read_b128 v[100:103], v19
  ds_read_b128 v[104:107], v15
  ds_read_b128 v[108:111], v15 offset:4096
  s_waitcnt lgkmcnt(9)
  v_mfma_f32_32x32x16_bf16 v[112:127], v[68:71], v[64:67], v[112:127]
  v_mfma_f32_32x32x16_bf16 v[128:143], v[72:75], v[64:67], v[128:143]
  s_waitcnt lgkmcnt(6)
  v_mfma_f32_32x32x16_bf16 v[112:127], v[80:83], v[76:79], v[112:127]
  v_mfma_f32_32x32x16_bf16 v[128:143], v[84:87], v[76:79], v[128:143]
  s_waitcnt lgkmcnt(3)
  v_mfma_f32_32x32x16_bf16 v[112:127], v[92:95], v[88:91], v[112:127]
  v_mfma_f32_32x32x16_bf16 v[128:143], v[96:99], v[88:91], v[128:143]
  s_waitcnt lgkmcnt(0)
  v_mfma_f32_32x32x16_bf16 v[112:127], v[104:107], v[100:103], v[112:127]
  v_mfma_f32_32x32x16_bf16 v[128:143], v[108:111], v[100:103], v[128:143]
  v_add_u32 v12, 20480, v12
  v_add_u32 v13, 20480, v13
  v_add_u32 v14, 20480, v14
  v_add_u32 v15, 20480, v15
  v_add_u32 v16, 20480, v16
  v_add_u32 v17, 20480, v17
  v_add_u32 v18, 20480, v18
  v_add_u32 v19, 20480, v19
  s_barrier
  ds_read_b128 v[64:67], v16
  ds_read_b128 v[68:71], v12
  ds_read_b128 v[72:75], v12 offset:4096
  ds_read_b128 v[76:79], v17
  ds_read_b128 v[80:83], v13
  ds_read_b128 v[84:87], v13 offset:4096
  ds_read_b128 v[88:91], v18
  ds_read_b128 v[92:95], v14
  ds_read_b128 v[96:99], v14 offset:4096
  ds_read_b128 v[100:103], v19
  ds_read_b128 v[104:107], v15
  ds_read_b128 v[108:111], v15 offset:4096
  s_waitcnt lgkmcnt(9)
  v_mfma_f32_32x32x16_bf16 v[112:127], v[68:71], v[64:67], v[112:127]
  v_mfma_f32_32x32x16_bf16 v[128:143], v[72:75], v[64:67], v[128:143]
  s_waitcnt lgkmcnt(6)
  v_mfma_f32_32x32x16_bf16 v[112:127], v[80:83], v[76:79], v[112:127]
  v_mfma_f32_32x32x16_bf16 v[128:143], v[84:87], v[76:79], v[128:143]
  s_waitcnt lgkmcnt(3)
  v_mfma_f32_32x32x16_bf16 v[112:127], v[92:95], v[88:91], v[112:127]
  v_mfma_f32_32x32x16_bf16 v[128:143], v[96:99], v[88:91], v[128:143]
  s_waitcnt lgkmcnt(0)
  v_mfma_f32_32x32x16_bf16 v[112:127], v[104:107], v[100:103], v[112:127]
  v_mfma_f32_32x32x16_bf16 v[128:143], v[108:111], v[100:103], v[128:143]
  v_add_u32 v12, 20480, v12
  v_add_u32 v13, 20480, v13
  v_add_u32 v14, 20480, v14
  v_add_u32 v15, 20480, v15
  v_add_u32 v16, 20480, v16
  v_add_u32 v17, 20480, v17
  v_add_u32 v18, 20480, v18
  v_add_u32 v19, 20480, v19
  s_barrier
  ds_read_b128 v[64:67], v16
  ds_read_b128 v[68:71], v12
  ds_read_b128 v[72:75], v12 offset:4096
  ds_read_b128 v[76:79], v17
  ds_read_b128 v[80:83], v13
  ds_read_b128 v[84:87], v13 offset:4096
  ds_read_b128 v[88:91], v18
  ds_read_b128 v[92:95], v14
  ds_read_b128 v[96:99], v14 offset:4096
  ds_read_b128 v[100:103], v19
  ds_read_b128 v[104:107], v15
  ds_read_b128 v[108:111], v15 offset:4096
  s_waitcnt lgkmcnt(9)
  v_mfma_f32_32x32x16_bf16 v[112:127], v[68:71], v[64:67], v[112:127]
  v_mfma_f32_32x32x16_bf16 v[128:143], v[72:75], v[64:67], v[128:143]
  s_waitcnt lgkmcnt(6)
  v_mfma_f32_32x32x16_bf16 v[112:127], v[80:83], v[76:79], v[112:127]
  v_mfma_f32_32x32x16_bf16 v[128:143], v[84:87], v[76:79], v[128:143]
  s_waitcnt lgkmcnt(3)
  v_mfma_f32_32x32x16_bf16 v[112:127], v[92:95], v[88:91], v[112:127]
  v_mfma_f32_32x32x16_bf16 v[128:143], v[96:99], v[88:91], v[128:143]
  s_waitcnt lgkmcnt(0)
  v_mfma_f32_32x32x16_bf16 v[112:127], v[104:107], v[100:103], v[112:127]
  v_mfma_f32_32x32x16_bf16 v[128:143], v[108:111], v[100:103], v[128:143]
  v_add_u32 v12, 20480, v12
  v_add_u32 v13, 20480, v13
  v_add_u32 v14, 20480, v14
  v_add_u32 v15, 20480, v15
  v_add_u32 v16, 20480, v16
  v_add_u32 v17, 20480, v17
  v_add_u32 v18, 20480, v18
  v_add_u32 v19, 20480, v19
  s_barrier
  ds_read_b128 v[64:67], v16
  ds_read_b128 v[68:71], v12
  ds_read_b128 v[72:75], v12 offset:4096
  ds_read_b128 v[76:79], v17
  ds_read_b128 v[80:83], v13
  ds_read_b128 v[84:87], v13 offset:4096
  ds_read_b128 v[88:91], v18
  ds_read_b128 v[92:95], v14
  ds_read_b128 v[96:99], v14 offset:4096
  ds_read_b128 v[100:103], v19
  ds_read_b128 v[104:107], v15
  ds_read_b128 v[108:111], v15 offset:4096
  s_waitcnt lgkmcnt(9)
  v_mfma_f32_32x32x16_bf16 v[112:127], v[68:71], v[64:67], v[112:127]
  v_mfma_f32_32x32x16_bf16 v[128:143], v[72:75], v[64:67], v[128:143]
  s_waitcnt lgkmcnt(6)
  v_mfma_f32_32x32x16_bf16 v[112:127], v[80:83], v[76:79], v[112:127]
  v_mfma_f32_32x32x16_bf16 v[128:143], v[84:87], v[76:79], v[128:143]
  s_waitcnt lgkmcnt(3)
  v_mfma_f32_32x32x16_bf16 v[112:127], v[92:95], v[88:91], v[112:127]
  v_mfma_f32_32x32x16_bf16 v[128:143], v[96:99], v[88:91], v[128:143]
  s_waitcnt lgkmcnt(0)
  v_mfma_f32_32x32x16_bf16 v[112:127], v[104:107], v[100:103], v[112:127]
  v_mfma_f32_32x32x16_bf16 v[128:143], v[108:111], v[100:103], v[128:143]
  s_nop 15
  v_cvt_pk_bf16_f32 v24, v112, v113
  v_cvt_pk_bf16_f32 v25, v114, v115
  v_cvt_pk_bf16_f32 v26, v116, v117
  v_cvt_pk_bf16_f32 v27, v118, v119
  v_cvt_pk_bf16_f32 v28, v120, v121
  v_cvt_pk_bf16_f32 v29, v122, v123
  v_cvt_pk_bf16_f32 v30, v124, v125
  v_cvt_pk_bf16_f32 v31, v126, v127
  s_nop 1
  v_permlane32_swap_b32 v24, v26
  v_permlane32_swap_b32 v25, v27
  v_permlane32_swap_b32 v28, v30
  v_permlane32_swap_b32 v29, v31
  buffer_store_dwordx4 v[24:27], v5, s[32:35], s55 offen offset:0
  buffer_store_dwordx4 v[28:31], v5, s[32:35], s55 offen offset:1024
  v_cvt_pk_bf16_f32 v32, v128, v129
  v_cvt_pk_bf16_f32 v33, v130, v131
  v_cvt_pk_bf16_f32 v34, v132, v133
  v_cvt_pk_bf16_f32 v35, v134, v135
  v_cvt_pk_bf16_f32 v36, v136, v137
  v_cvt_pk_bf16_f32 v37, v138, v139
  v_cvt_pk_bf16_f32 v38, v140, v141
  v_cvt_pk_bf16_f32 v39, v142, v143
  s_nop 1
  v_permlane32_swap_b32 v32, v34
  v_permlane32_swap_b32 v33, v35
  v_permlane32_swap_b32 v36, v38
  v_permlane32_swap_b32 v37, v39
  buffer_store_dwordx4 v[32:35], v5, s[32:35], s55 offen offset:2048
  buffer_store_dwordx4 v[36:39], v5, s[32:35], s55 offen offset:3072
  s_branch L_end_1
L_w8_4:
  v_lshrrev_b32 v31, 2, v4
  v_and_b32 v30, 3, v4
  v_lshlrev_b32 v30, 2, v30
  v_lshl_add_u32 v31, v31, 7, v30
  s_waitcnt vmcnt(6)
  s_barrier
  s_lshl_b32 s74, s71, 7
  s_add_u32 s74, s74, s58
  s_add_u32 s75, s60, s72
  s_add_u32 m0, s75, 0
  s_nop 0
  buffer_load_dwordx4 v40, s[24:27], s74 offen lds
  s_add_u32 m0, s75, 1024
  s_nop 0
  buffer_load_dwordx4 v41, s[24:27], s74 offen lds
  s_add_u32 m0, s75, 2048
  s_nop 0
  buffer_load_dwordx4 v42, s[24:27], s74 offen lds
  s_add_u32 m0, s75, 3072
  s_nop 0
  buffer_load_dwordx4 v43, s[24:27], s74 offen lds
  s_lshl_b32 s74, s71, 17
  s_add_u32 s74, s74, s59
  s_add_u32 s75, s61, s72
  s_add_u32 m0, s75, 16384
  s_nop 0
  buffer_load_dwordx4 v44, s[28:31], s74 offen lds
  s_add_u32 m0, s75, 17408
  s_nop 0
  buffer_load_dwordx4 v45, s[28:31], s74 offen lds
  s_add_u32 s71, s71, 1
  s_and_b32 s71, s71, 15
  s_add_u32 s72, s72, 24576
  s_cmp_eq_u32 s72, 98304
  s_cselect_b32 s72, 0, s72
  v_mov_b32 v29, 0
  global_load_dword v28, v29, s[62:63] sc0 sc1
  s_waitcnt vmcnt(7)
  s_barrier
  s_lshl_b32 s74, s71, 7
  s_add_u32 s74, s74, s58
  s_add_u32 s75, s60, s72
  s_add_u32 m0, s75, 0
  s_nop 0
  buffer_load_dwordx4 v40, s[24:27], s74 offen lds
  s_add_u32 m0, s75, 1024
  s_nop 0
  buffer_load_dwordx4 v41, s[24:27], s74 offen lds
  s_add_u32 m0, s75, 2048
  s_nop 0
  buffer_load_dwordx4 v42, s[24:27], s74 offen lds
  s_add_u32 m0, s75, 3072
  s_nop 0
  buffer_load_dwordx4 v43, s[24:27], s74 offen lds
  s_lshl_b32 s74, s71, 17
  s_add_u32 s74, s74, s59
  s_add_u32 s75, s61, s72
  s_add_u32 m0, s75, 16384
  s_nop 0
  buffer_load_dwordx4 v44, s[28:31], s74 offen lds
  s_add_u32 m0, s75, 17408
  s_nop 0
  buffer_load_dwordx4 v45, s[28:31], s74 offen lds
  s_add_u32 s71, s71, 1
  s_and_b32 s71, s71, 15
  s_add_u32 s72, s72, 24576
  s_cmp_eq_u32 s72, 98304
  s_cselect_b32 s72, 0, s72
  s_waitcnt vmcnt(7)
  s_barrier
  s_lshl_b32 s74, s71, 7
  s_add_u32 s74, s74, s58
  s_add_u32 s75, s60, s72
  s_add_u32 m0, s75, 0
  s_nop 0
  buffer_load_dwordx4 v40, s[24:27], s74 offen lds
  s_add_u32 m0, s75, 1024
  s_nop 0
  buffer_load_dwordx4 v41, s[24:27], s74 offen lds
  s_add_u32 m0, s75, 2048
  s_nop 0
  buffer_load_dwordx4 v42, s[24:27], s74 offen lds
  s_add_u32 m0, s75, 3072
  s_nop 0
  buffer_load_dwordx4 v43, s[24:27], s74 offen lds
  s_lshl_b32 s74, s71, 17
  s_add_u32 s74, s74, s59
  s_add_u32 s75, s61, s72
  s_add_u32 m0, s75, 16384
  s_nop 0
  buffer_load_dwordx4 v44, s[28:31], s74 offen lds
  s_add_u32 m0, s75, 17408
  s_nop 0
  buffer_load_dwordx4 v45, s[28:31], s74 offen lds
  s_add_u32 s71, s71, 1
  s_and_b32 s71, s71, 15
  s_add_u32 s72, s72, 24576
  s_cmp_eq_u32 s72, 98304
  s_cselect_b32 s72, 0, s72
  s_waitcnt vmcnt(6)
  s_barrier
  s_lshl_b32 s74, s71, 7
  s_add_u32 s74, s74, s58
  s_add_u32 s75, s60, s72
  s_add_u32 m0, s75, 0
  s_nop 0
  buffer_load_dwordx4 v40, s[24:27], s74 offen lds
  s_add_u32 m0, s75, 1024
  s_nop 0
  buffer_load_dwordx4 v41, s[24:27], s74 offen lds
  s_add_u32 m0, s75, 2048
  s_nop 0
  buffer_load_dwordx4 v42, s[24:27], s74 offen lds
  s_add_u32 m0, s75, 3072
  s_nop 0
  buffer_load_dwordx4 v43, s[24:27], s74 offen lds
  s_lshl_b32 s74, s71, 17
  s_add_u32 s74, s74, s59
  s_add_u32 s75, s61, s72
  s_add_u32 m0, s75, 16384
  s_nop 0
  buffer_load_dwordx4 v44, s[28:31], s74 offen lds
  s_add_u32 m0, s75, 17408
  s_nop 0
  buffer_load_dwordx4 v45, s[28:31], s74 offen lds
  s_add_u32 s71, s71, 1
  s_and_b32 s71, s71, 15
  s_add_u32 s72, s72, 24576
  s_cmp_eq_u32 s72, 98304
  s_cselect_b32 s72, 0, s72
  buffer_load_dword v30, v31, s[32:35], 0 offen offset:0 sc0 sc1
  s_waitcnt vmcnt(7)
  s_barrier
  s_lshl_b32 s74, s71, 7
  s_add_u32 s74, s74, s58
  s_add_u32 s75, s60, s72
  s_add_u32 m0, s75, 0
  s_nop 0
  buffer_load_dwordx4 v40, s[24:27], s74 offen lds
  s_add_u32 m0, s75, 1024
  s_nop 0
  buffer_load_dwordx4 v41, s[24:27], s74 offen lds
  s_add_u32 m0, s75, 2048
  s_nop 0
  buffer_load_dwordx4 v42, s[24:27], s74 offen lds
  s_add_u32 m0, s75, 3072
  s_nop 0
  buffer_load_dwordx4 v43, s[24:27], s74 offen lds
  s_lshl_b32 s74, s71, 17
  s_add_u32 s74, s74, s59
  s_add_u32 s75, s61, s72
  s_add_u32 m0, s75, 16384
  s_nop 0
  buffer_load_dwordx4 v44, s[28:31], s74 offen lds
  s_add_u32 m0, s75, 17408
  s_nop 0
  buffer_load_dwordx4 v45, s[28:31], s74 offen lds
  s_add_u32 s71, s71, 1
  s_and_b32 s71, s71, 15
  s_add_u32 s72, s72, 24576
  s_cmp_eq_u32 s72, 98304
  s_cselect_b32 s72, 0, s72
  s_waitcnt vmcnt(7)
  s_barrier
  s_lshl_b32 s74, s71, 7
  s_add_u32 s74, s74, s58
  s_add_u32 s75, s60, s72
  s_add_u32 m0, s75, 0
  s_nop 0
  buffer_load_dwordx4 v40, s[24:27], s74 offen lds
  s_add_u32 m0, s75, 1024
  s_nop 0
  buffer_load_dwordx4 v41, s[24:27], s74 offen lds
  s_add_u32 m0, s75, 2048
  s_nop 0
  buffer_load_dwordx4 v42, s[24:27], s74 offen lds
  s_add_u32 m0, s75, 3072
  s_nop 0
  buffer_load_dwordx4 v43, s[24:27], s74 offen lds
  s_lshl_b32 s74, s71, 17
  s_add_u32 s74, s74, s59
  s_add_u32 s75, s61, s72
  s_add_u32 m0, s75, 16384
  s_nop 0
  buffer_load_dwordx4 v44, s[28:31], s74 offen lds
  s_add_u32 m0, s75, 17408
  s_nop 0
  buffer_load_dwordx4 v45, s[28:31], s74 offen lds
  s_add_u32 s71, s71, 1
  s_and_b32 s71, s71, 15
  s_add_u32 s72, s72, 24576
  s_cmp_eq_u32 s72, 98304
  s_cselect_b32 s72, 0, s72
  s_waitcnt vmcnt(12)
  v_mul_lo_u32 v30, v30, v28
  v_cmp_eq_u32 vcc, 0x01010101, v30
  s_nop 3
  s_cmp_eq_u64 vcc, -1
  s_cselect_b32 s53, 0, 0x40000000
  s_cselect_b64 exec, 0, -1
  buffer_load_dword v30, v31, s[32:35], 0 offen offset:0 sc0 sc1
  s_mov_b64 exec, -1
  s_mov_b32 m0, 0
  s_add_u32 s64, s53, 0
  buffer_load_dwordx4 v5, s[36:39], s64 offen lds
  s_mov_b32 m0, 1024
  s_add_u32 s64, s53, 1024
  buffer_load_dwordx4 v5, s[36:39], s64 offen lds
  s_mov_b32 m0, 2048
  s_add_u32 s64, s53, 2048
  buffer_load_dwordx4 v5, s[36:39], s64 offen lds
  s_mov_b32 m0, 3072
  s_add_u32 s64, s53, 3072
  buffer_load_dwordx4 v5, s[36:39], s64 offen lds
  s_mov_b32 m0, 4096
  s_add_u32 s64, s53, 4096
  buffer_load_dwordx4 v5, s[36:39], s64 offen lds
  s_mov_b32 m0, 5120
  s_add_u32 s64, s53, 5120
  buffer_load_dwordx4 v5, s[36:39], s64 offen lds
  s_mov_b32 m0, 6144
  s_add_u32 s64, s53, 6144
  buffer_load_dwordx4 v5, s[36:39], s64 offen lds
  s_mov_b32 m0, 7168
  s_add_u32 s64, s53, 7168
  buffer_load_dwordx4 v5, s[36:39], s64 offen lds
  s_mov_b32 m0, 8192
  s_add_u32 s64, s53, 8192
  buffer_load_dwordx4 v5, s[36:39], s64 offen lds
  s_mov_b32 m0, 9216
  s_add_u32 s64, s53, 9216
  buffer_load_dwordx4 v5, s[36:39], s64 offen lds
  s_mov_b32 m0, 10240
  s_add_u32 s64, s53, 10240
  buffer_load_dwordx4 v5, s[36:39], s64 offen lds
  s_mov_b32 m0, 11264
  s_add_u32 s64, s53, 11264
  buffer_load_dwordx4 v5, s[36:39], s64 offen lds
  s_mov_b32 m0, 12288
  s_add_u32 s64, s53, 12288
  buffer_load_dwordx4 v5, s[36:39], s64 offen lds
  s_mov_b32 m0, 13312
  s_add_u32 s64, s53, 13312
  buffer_load_dwordx4 v5, s[36:39], s64 offen lds
  s_mov_b32 m0, 14336
  s_add_u32 s64, s53, 14336
  buffer_load_dwordx4 v5, s[36:39], s64 offen lds
  s_mov_b32 m0, 15360
  s_add_u32 s64, s53, 15360
  buffer_load_dwordx4 v5, s[36:39], s64 offen lds
  s_waitcnt vmcnt(23)
  s_barrier
  s_mov_b32 m0, 16384
  s_add_u32 s64, s53, 16384
  buffer_load_dwordx4 v5, s[36:39], s64 offen lds
  s_mov_b32 m0, 17408
  s_add_u32 s64, s53, 17408
  buffer_load_dwordx4 v5, s[36:39], s64 offen lds
  s_mov_b32 m0, 18432
  s_add_u32 s64, s53, 18432
  buffer_load_dwordx4 v5, s[36:39], s64 offen lds
  s_mov_b32 m0, 19456
  s_add_u32 s64, s53, 19456
  buffer_load_dwordx4 v5, s[36:39], s64 offen lds
  s_mov_b32 m0, 20480
  s_add_u32 s64, s53, 20480
  buffer_load_dwordx4 v5, s[36:39], s64 offen lds
  s_mov_b32 m0, 21504
  s_add_u32 s64, s53, 21504
  buffer_load_dwordx4 v5, s[36:39], s64 offen lds
  s_mov_b32 m0, 22528
  s_add_u32 s64, s53, 22528
  buffer_load_dwordx4 v5, s[36:39], s64 offen lds
  s_mov_b32 m0, 23552
  s_add_u32 s64, s53, 23552
  buffer_load_dwordx4 v5, s[36:39], s64 offen lds
  s_mov_b32 m0, 24576
  s_add_u32 s64, s53, 24576
  buffer_load_dwordx4 v5, s[36:39], s64 offen lds
  s_mov_b32 m0, 25600
  s_add_u32 s64, s53, 25600
  buffer_load_dwordx4 v5, s[36:39], s64 offen lds
  s_mov_b32 m0, 26624
  s_add_u32 s64, s53, 26624
  buffer_load_dwordx4 v5, s[36:39], s64 offen lds
  s_mov_b32 m0, 27648
  s_add_u32 s64, s53, 27648
  buffer_load_dwordx4 v5, s[36:39], s64 offen lds
  s_mov_b32 m0, 28672
  s_add_u32 s64, s53, 28672
  buffer_load_dwordx4 v5, s[36:39], s64 offen lds
  s_mov_b32 m0, 29696
  s_add_u32 s64, s53, 29696
  buffer_load_dwordx4 v5, s[36:39], s64 offen lds
  s_mov_b32 m0, 30720
  s_add_u32 s64, s53, 30720
  buffer_load_dwordx4 v5, s[36:39], s64 offen lds
  s_mov_b32 m0, 31744
  s_add_u32 s64, s53, 31744
  buffer_load_dwordx4 v5, s[36:39], s64 offen lds
  s_waitcnt vmcnt(33)
  s_barrier
  s_cmp_eq_u32 s53, 0
  s_cbranch_scc1 L_fok_10
  s_waitcnt vmcnt(0)
  v_mul_lo_u32 v30, v30, v28
  v_cmp_eq_u32 vcc, 0x01010101, v30
  s_nop 3
  s_cmp_eq_u64 vcc, -1
  s_cbranch_scc1 L_fgo_12
  s_mov_b32 s49, 0
  s_mov_b32 s48, 0
L_spl_13:
  v_readfirstlane_b32 s3, v28
  s_cmp_eq_u32 s3, 1
  s_cbranch_scc1 L_spa_15
  v_mov_b32 v29, 0
  global_load_dword v28, v29, s[62:63] sc0 sc1
  s_waitcnt vmcnt(0)
L_spa_15:
  buffer_load_dword v30, v31, s[32:35], 0 offen offset:0 sc0 sc1
  s_add_u32 s49, s49, 1
  s_waitcnt vmcnt(0)
  v_mul_lo_u32 v30, v30, v28
  v_cmp_eq_u32 vcc, 0x01010101, v30
  s_nop 3
  s_cmp_eq_u64 vcc, -1
  s_cbranch_scc1 L_spg_14
  s_sleep 6
  s_cmp_lt_u32 s49, 4096
  s_cbranch_scc1 L_spl_13
  s_mov_b32 s48, 1
L_spg_14:
  s_cmp_eq_u32 s48, 0
  s_cbranch_scc1 L_fgo_12
  v_mov_b32 v1, 163824
  v_mov_b32 v2, 1
  ds_write_b32 v1, v2
  s_waitcnt lgkmcnt(0)
  s_barrier
  s_barrier
  s_mov_b32 s49, 0
L_fbb_16:
  s_barrier
  s_barrier
  s_add_u32 s49, s49, 1
  s_cmp_lt_u32 s49, 256
  s_cbranch_scc1 L_fbb_16
  s_barrier
L_fgo_12:
  s_mov_b32 s53, 0
  s_mov_b32 m0, 0
  s_add_u32 s64, s53, 0
  buffer_load_dwordx4 v5, s[36:39], s64 offen lds
  s_mov_b32 m0, 1024
  s_add_u32 s64, s53, 1024
  buffer_load_dwordx4 v5, s[36:39], s64 offen lds
  s_mov_b32 m0, 2048
  s_add_u32 s64, s53, 2048
  buffer_load_dwordx4 v5, s[36:39], s64 offen lds
  s_mov_b32 m0, 3072
  s_add_u32 s64, s53, 3072
  buffer_load_dwordx4 v5, s[36:39], s64 offen lds
  s_mov_b32 m0, 4096
  s_add_u32 s64, s53, 4096
  buffer_load_dwordx4 v5, s[36:39], s64 offen lds
  s_mov_b32 m0, 5120
  s_add_u32 s64, s53, 5120
  buffer_load_dwordx4 v5, s[36:39], s64 offen lds
  s_mov_b32 m0, 6144
  s_add_u32 s64, s53, 6144
  buffer_load_dwordx4 v5, s[36:39], s64 offen lds
  s_mov_b32 m0, 7168
  s_add_u32 s64, s53, 7168
  buffer_load_dwordx4 v5, s[36:39], s64 offen lds
  s_mov_b32 m0, 8192
  s_add_u32 s64, s53, 8192
  buffer_load_dwordx4 v5, s[36:39], s64 offen lds
  s_mov_b32 m0, 9216
  s_add_u32 s64, s53, 9216
  buffer_load_dwordx4 v5, s[36:39], s64 offen lds
  s_mov_b32 m0, 10240
  s_add_u32 s64, s53, 10240
  buffer_load_dwordx4 v5, s[36:39], s64 offen lds
  s_mov_b32 m0, 11264
  s_add_u32 s64, s53, 11264
  buffer_load_dwordx4 v5, s[36:39], s64 offen lds
  s_mov_b32 m0, 12288
  s_add_u32 s64, s53, 12288
  buffer_load_dwordx4 v5, s[36:39], s64 offen lds
  s_mov_b32 m0, 13312
  s_add_u32 s64, s53, 13312
  buffer_load_dwordx4 v5, s[36:39], s64 offen lds
  s_mov_b32 m0, 14336
  s_add_u32 s64, s53, 14336
  buffer_load_dwordx4 v5, s[36:39], s64 offen lds
  s_mov_b32 m0, 15360
  s_add_u32 s64, s53, 15360
  buffer_load_dwordx4 v5, s[36:39], s64 offen lds
  s_mov_b32 m0, 16384
  s_add_u32 s64, s53, 16384
  buffer_load_dwordx4 v5, s[36:39], s64 offen lds
  s_mov_b32 m0, 17408
  s_add_u32 s64, s53, 17408
  buffer_load_dwordx4 v5, s[36:39], s64 offen lds
  s_mov_b32 m0, 18432
  s_add_u32 s64, s53, 18432
  buffer_load_dwordx4 v5, s[36:39], s64 offen lds
  s_mov_b32 m0, 19456
  s_add_u32 s64, s53, 19456
  buffer_load_dwordx4 v5, s[36:39], s64 offen lds
  s_mov_b32 m0, 20480
  s_add_u32 s64, s53, 20480
  buffer_load_dwordx4 v5, s[36:39], s64 offen lds
  s_mov_b32 m0, 21504
  s_add_u32 s64, s53, 21504
  buffer_load_dwordx4 v5, s[36:39], s64 offen lds
  s_mov_b32 m0, 22528
  s_add_u32 s64, s53, 22528
  buffer_load_dwordx4 v5, s[36:39], s64 offen lds
  s_mov_b32 m0, 23552
  s_add_u32 s64, s53, 23552
  buffer_load_dwordx4 v5, s[36:39], s64 offen lds
  s_mov_b32 m0, 24576
  s_add_u32 s64, s53, 24576
  buffer_load_dwordx4 v5, s[36:39], s64 offen lds
  s_mov_b32 m0, 25600
  s_add_u32 s64, s53, 25600
  buffer_load_dwordx4 v5, s[36:39], s64 offen lds
  s_mov_b32 m0, 26624
  s_add_u32 s64, s53, 26624
  buffer_load_dwordx4 v5, s[36:39], s64 offen lds
  s_mov_b32 m0, 27648
  s_add_u32 s64, s53, 27648
  buffer_load_dwordx4 v5, s[36:39], s64 offen lds
  s_mov_b32 m0, 28672
  s_add_u32 s64, s53, 28672
  buffer_load_dwordx4 v5, s[36:39], s64 offen lds
  s_mov_b32 m0, 29696
  s_add_u32 s64, s53, 29696
  buffer_load_dwordx4 v5, s[36:39], s64 offen lds
  s_mov_b32 m0, 30720
  s_add_u32 s64, s53, 30720
  buffer_load_dwordx4 v5, s[36:39], s64 offen lds
  s_mov_b32 m0, 31744
  s_add_u32 s64, s53, 31744
  buffer_load_dwordx4 v5, s[36:39], s64 offen lds
L_fok_10:
  v_mov_b32 v1, 163824
  v_mov_b32 v2, 0
  ds_write_b32 v1, v2
  s_waitcnt lgkmcnt(0)
  s_cmp_lt_u32 s50, 4
  s_cselect_b32 s16, s4, s6
  s_cselect_b32 s17, s5, s7
  s_mov_b32 s18, 2097152
  s_mov_b32 s19, 0x20000
  v_lshrrev_b32 v1, 4, v4
  v_and_b32 v2, 7, v4
  v_xor_b32 v1, v1, v2
  v_lshlrev_b32 v1, 4, v1
  v_lshrrev_b32 v2, 3, v4
  v_mul_u32_u24 v2, 640, v2
  v_add_u32 v12, v2, v1
  v_lshrrev_b32 v1, 4, v4
  v_and_b32 v2, 7, v4
  v_xor_b32 v1, v1, v2
  v_lshlrev_b32 v1, 4, v1
  v_lshrrev_b32 v2, 3, v4
  v_lshl_add_u32 v14, v2, 12, v1
  v_lshrrev_b32 v1, 4, v4
  v_add_u32 v1, 4, v1
  v_and_b32 v2, 7, v4
  v_xor_b32 v1, v1, v2
  v_lshlrev_b32 v1, 4, v1
  v_lshrrev_b32 v2, 3, v4
  v_mul_u32_u24 v2, 640, v2
  v_add_u32 v13, v2, v1
  v_lshrrev_b32 v1, 4, v4
  v_add_u32 v1, 4, v1
  v_and_b32 v2, 7, v4
  v_xor_b32 v1, v1, v2
  v_lshlrev_b32 v1, 4, v1
  v_lshrrev_b32 v2, 3, v4
  v_lshl_add_u32 v15, v2, 12, v1
  s_mul_i32 s54, s50, 368640
  s_mul_i32 s55, s51, 40960
  s_add_u32 s54, s54, s55
  s_add_u32 s54, s54, 10485760
  s_mul_i32 s55, s52, 393216
  s_and_b32 s56, s50, 1
  s_lshl_b32 s56, s56, 11
  s_add_u32 s55, s55, s56
  s_cmp_ge_u32 s66, 27
  s_cselect_b32 s54, 0x40000000, s54
  s_cselect_b32 s55, 0x40000000, s55
  s_mov_b32 s56, 49152
  s_mov_b32 s45, 32768
  s_mov_b32 s46, 32768
  s_waitcnt vmcnt(16)
  s_barrier
  s_waitcnt vmcnt(0)
  s_mov_b32 s20, s12
  s_mov_b32 s21, s13
  s_mov_b32 s22, 2097152
  s_mov_b32 s23, 0x20000
  s_lshl_b32 s53, s66, 16
  v_lshlrev_b32 v20, 6, v4
  s_bfe_u32 s57, s65, 0x10001
  s_mul_i32 s57, s57, 320
  s_mul_i32 s49, s66, 10
  s_add_u32 s57, s57, s49
  s_lshl_b32 s57, s57, 13
  s_lshr_b32 s49, s65, 2
  s_lshl_b32 s49, s49, 12
  s_add_u32 s57, s57, s49
  s_mov_b32 s49, 0xe38e38f
  v_add_u32 v1, 0, v4
  v_min_u32 v1, 179, v1
  v_mul_hi_u32 v2, v1, s49
  v_mul_u32_u24 v3, 18, v2
  v_sub_u32 v1, v1, v3
  v_lshlrev_b32 v1, 6, v1
  v_lshl_add_u32 v16, v2, 13, v1
  v_add_u32 v1, 64, v4
  v_min_u32 v1, 179, v1
  v_mul_hi_u32 v2, v1, s49
  v_mul_u32_u24 v3, 18, v2
  v_sub_u32 v1, v1, v3
  v_lshlrev_b32 v1, 6, v1
  v_lshl_add_u32 v17, v2, 13, v1
  v_add_u32 v1, 128, v4
  v_min_u32 v1, 179, v1
  v_mul_hi_u32 v2, v1, s49
  v_mul_u32_u24 v3, 18, v2
  v_sub_u32 v1, v1, v3
  v_lshlrev_b32 v1, 6, v1
  v_lshl_add_u32 v18, v2, 13, v1
  s_mov_b32 s47, 0
L_ld2_17:
  s_barrier
  s_add_u32 m0, s46, 0
  s_add_u32 s64, s45, 0
  buffer_load_dwordx4 v5, s[36:39], s64 offen lds
  s_add_u32 m0, s46, 1024
  s_add_u32 s64, s45, 1024
  buffer_load_dwordx4 v5, s[36:39], s64 offen lds
  s_add_u32 m0, s46, 2048
  s_add_u32 s64, s45, 2048
  buffer_load_dwordx4 v5, s[36:39], s64 offen lds
  s_add_u32 m0, s46, 3072
  s_add_u32 s64, s45, 3072
  buffer_load_dwordx4 v5, s[36:39], s64 offen lds
  s_add_u32 m0, s46, 4096
  s_add_u32 s64, s45, 4096
  buffer_load_dwordx4 v5, s[36:39], s64 offen lds
  s_add_u32 m0, s46, 5120
  s_add_u32 s64, s45, 5120
  buffer_load_dwordx4 v5, s[36:39], s64 offen lds
  s_add_u32 m0, s46, 6144
  s_add_u32 s64, s45, 6144
  buffer_load_dwordx4 v5, s[36:39], s64 offen lds
  s_add_u32 m0, s46, 7168
  s_add_u32 s64, s45, 7168
  buffer_load_dwordx4 v5, s[36:39], s64 offen lds
  s_add_u32 m0, s46, 8192
  s_add_u32 s64, s45, 8192
  buffer_load_dwordx4 v5, s[36:39], s64 offen lds
  s_add_u32 m0, s46, 9216
  s_add_u32 s64, s45, 9216
  buffer_load_dwordx4 v5, s[36:39], s64 offen lds
  s_add_u32 m0, s46, 10240
  s_add_u32 s64, s45, 10240
  buffer_load_dwordx4 v5, s[36:39], s64 offen lds
  s_add_u32 m0, s46, 11264
  s_add_u32 s64, s45, 11264
  buffer_load_dwordx4 v5, s[36:39], s64 offen lds
  s_add_u32 m0, s46, 12288
  s_add_u32 s64, s45, 12288
  buffer_load_dwordx4 v5, s[36:39], s64 offen lds
  s_add_u32 m0, s46, 13312
  s_add_u32 s64, s45, 13312
  buffer_load_dwordx4 v5, s[36:39], s64 offen lds
  s_add_u32 m0, s46, 14336
  s_add_u32 s64, s45, 14336
  buffer_load_dwordx4 v5, s[36:39], s64 offen lds
  s_add_u32 m0, s46, 15360
  s_add_u32 s64, s45, 15360
  buffer_load_dwordx4 v5, s[36:39], s64 offen lds
  s_add_u32 s45, s45, 16384
  s_add_u32 s46, s46, 16384
  s_cmp_eq_u32 s46, 49152
  s_cselect_b32 s46, 0, s46
  buffer_load_dword v21, v20, s[20:23], s53 offen
  s_add_u32 s53, s53, 4096
  buffer_load_dword v22, v20, s[20:23], s53 offen
  s_add_u32 s53, s53, 4096
  s_add_u32 s47, s47, 1
  s_cmp_lt_u32 s47, 8
  s_waitcnt vmcnt(2)
  s_cbranch_scc1 L_ld2_17
  s_mov_b32 s20, s8
  s_mov_b32 s21, s9
  s_mov_b32 s22, 8388608
  s_mov_b32 s23, 0x20000
  s_mov_b32 s24, s10
  s_mov_b32 s25, s11
  s_mov_b32 s26, 8388608
  s_mov_b32 s27, 0x20000
  s_barrier
  s_add_u32 m0, s46, 0
  s_add_u32 s64, s45, 0
  buffer_load_dwordx4 v5, s[36:39], s64 offen lds
  s_add_u32 m0, s46, 1024
  s_add_u32 s64, s45, 1024
  buffer_load_dwordx4 v5, s[36:39], s64 offen lds
  s_add_u32 m0, s46, 2048
  s_add_u32 s64, s45, 2048
  buffer_load_dwordx4 v5, s[36:39], s64 offen lds
  s_add_u32 m0, s46, 3072
  s_add_u32 s64, s45, 3072
  buffer_load_dwordx4 v5, s[36:39], s64 offen lds
  s_add_u32 m0, s46, 4096
  s_add_u32 s64, s45, 4096
  buffer_load_dwordx4 v5, s[36:39], s64 offen lds
  s_add_u32 m0, s46, 5120
  s_add_u32 s64, s45, 5120
  buffer_load_dwordx4 v5, s[36:39], s64 offen lds
  s_add_u32 m0, s46, 6144
  s_add_u32 s64, s45, 6144
  buffer_load_dwordx4 v5, s[36:39], s64 offen lds
  s_add_u32 m0, s46, 7168
  s_add_u32 s64, s45, 7168
  buffer_load_dwordx4 v5, s[36:39], s64 offen lds
  s_add_u32 m0, s46, 8192
  s_add_u32 s64, s45, 8192
  buffer_load_dwordx4 v5, s[36:39], s64 offen lds
  s_add_u32 m0, s46, 9216
  s_add_u32 s64, s45, 9216
  buffer_load_dwordx4 v5, s[36:39], s64 offen lds
  s_add_u32 m0, s46, 10240
  s_add_u32 s64, s45, 10240
  buffer_load_dwordx4 v5, s[36:39], s64 offen lds
  s_add_u32 m0, s46, 11264
  s_add_u32 s64, s45, 11264
  buffer_load_dwordx4 v5, s[36:39], s64 offen lds
  s_add_u32 m0, s46, 12288
  s_add_u32 s64, s45, 12288
  buffer_load_dwordx4 v5, s[36:39], s64 offen lds
  s_add_u32 m0, s46, 13312
  s_add_u32 s64, s45, 13312
  buffer_load_dwordx4 v5, s[36:39], s64 offen lds
  s_add_u32 m0, s46, 14336
  s_add_u32 s64, s45, 14336
  buffer_load_dwordx4 v5, s[36:39], s64 offen lds
  s_add_u32 m0, s46, 15360
  s_add_u32 s64, s45, 15360
  buffer_load_dwordx4 v5, s[36:39], s64 offen lds
  s_add_u32 s45, s45, 16384
  s_add_u32 s46, s46, 16384
  s_cmp_eq_u32 s46, 49152
  s_cselect_b32 s46, 0, s46
  buffer_load_dword v21, v16, s[20:23], s57 offen
  buffer_load_dword v22, v16, s[24:27], s57 offen
  buffer_load_dword v30, v31, s[32:35], 0 offen offset:2048 sc0 sc1
  s_waitcnt vmcnt(3)
  s_barrier
  s_add_u32 m0, s46, 0
  s_add_u32 s64, s45, 0
  buffer_load_dwordx4 v5, s[36:39], s64 offen lds
  s_add_u32 m0, s46, 1024
  s_add_u32 s64, s45, 1024
  buffer_load_dwordx4 v5, s[36:39], s64 offen lds
  s_add_u32 m0, s46, 2048
  s_add_u32 s64, s45, 2048
  buffer_load_dwordx4 v5, s[36:39], s64 offen lds
  s_add_u32 m0, s46, 3072
  s_add_u32 s64, s45, 3072
  buffer_load_dwordx4 v5, s[36:39], s64 offen lds
  s_add_u32 m0, s46, 4096
  s_add_u32 s64, s45, 4096
  buffer_load_dwordx4 v5, s[36:39], s64 offen lds
  s_add_u32 m0, s46, 5120
  s_add_u32 s64, s45, 5120
  buffer_load_dwordx4 v5, s[36:39], s64 offen lds
  s_add_u32 m0, s46, 6144
  s_add_u32 s64, s45, 6144
  buffer_load_dwordx4 v5, s[36:39], s64 offen lds
  s_add_u32 m0, s46, 7168
  s_add_u32 s64, s45, 7168
  buffer_load_dwordx4 v5, s[36:39], s64 offen lds
  s_add_u32 m0, s46, 8192
  s_add_u32 s64, s45, 8192
  buffer_load_dwordx4 v5, s[36:39], s64 offen lds
  s_add_u32 m0, s46, 9216
  s_add_u32 s64, s45, 9216
  buffer_load_dwordx4 v5, s[36:39], s64 offen lds
  s_add_u32 m0, s46, 10240
  s_add_u32 s64, s45, 10240
  buffer_load_dwordx4 v5, s[36:39], s64 offen lds
  s_add_u32 m0, s46, 11264
  s_add_u32 s64, s45, 11264
  buffer_load_dwordx4 v5, s[36:39], s64 offen lds
  s_add_u32 m0, s46, 12288
  s_add_u32 s64, s45, 12288
  buffer_load_dwordx4 v5, s[36:39], s64 offen lds
  s_add_u32 m0, s46, 13312
  s_add_u32 s64, s45, 13312
  buffer_load_dwordx4 v5, s[36:39], s64 offen lds
  s_add_u32 m0, s46, 14336
  s_add_u32 s64, s45, 14336
  buffer_load_dwordx4 v5, s[36:39], s64 offen lds
  s_add_u32 m0, s46, 15360
  s_add_u32 s64, s45, 15360
  buffer_load_dwordx4 v5, s[36:39], s64 offen lds
  s_add_u32 s45, s45, 16384
  s_add_u32 s46, s46, 16384
  s_cmp_eq_u32 s46, 49152
  s_cselect_b32 s46, 0, s46
  s_waitcnt vmcnt(16)
  v_mul_lo_u32 v30, v30, v28
  v_cmp_eq_u32 vcc, 0x01010101, v30
  s_nop 3
  s_cmp_eq_u64 vcc, -1
  s_cbranch_scc1 L_ok2_18
  s_mov_b32 s49, 0
  s_mov_b32 s48, 0
L_spl_19:
  v_readfirstlane_b32 s3, v28
  s_cmp_eq_u32 s3, 1
  s_cbranch_scc1 L_spa_21
  v_mov_b32 v29, 0
  global_load_dword v28, v29, s[62:63] sc0 sc1
  s_waitcnt vmcnt(0)
L_spa_21:
  buffer_load_dword v30, v31, s[32:35], 0 offen offset:2048 sc0 sc1
  s_add_u32 s49, s49, 1
  s_waitcnt vmcnt(0)
  v_mul_lo_u32 v30, v30, v28
  v_cmp_eq_u32 vcc, 0x01010101, v30
  s_nop 3
  s_cmp_eq_u64 vcc, -1
  s_cbranch_scc1 L_spg_20
  s_sleep 6
  s_cmp_lt_u32 s49, 4096
  s_cbranch_scc1 L_spl_19
  s_mov_b32 s48, 1
L_spg_20:
  s_cmp_eq_u32 s48, 0
  s_cbranch_scc1 L_ok2_18
  s_cmp_ge_u32 s66, 27
  s_cbranch_scc1 L_ok2_18
  s_mov_b32 s40, s54
  s_mov_b32 s41, s55
  s_mov_b32 s20, s100
  s_mov_b32 s21, s101
  s_mov_b32 s22, 4194304
  s_mov_b32 s23, 0x20000
  s_mul_i32 s48, s51, 320
  s_mov_b32 s47, 0
L_ffb_22:
  s_add_u32 s44, s48, s47
  v_mov_b32 v64, 0
  v_mov_b32 v65, 0
  v_mov_b32 v66, 0
  v_mov_b32 v67, 0
  v_mov_b32 v68, 0
  v_mov_b32 v69, 0
  v_mov_b32 v70, 0
  v_mov_b32 v71, 0
  v_mov_b32 v72, 0
  v_mov_b32 v73, 0
  v_mov_b32 v74, 0
  v_mov_b32 v75, 0
  v_mov_b32 v76, 0
  v_mov_b32 v77, 0
  v_mov_b32 v78, 0
  v_mov_b32 v79, 0
  s_mov_b32 s53, 0x33333334
  s_mul_hi_u32 s54, s44, s53
  s_mul_i32 s53, s54, 5
  s_sub_u32 s53, s44, s53
  s_lshl_b32 s53, s53, 6
  v_add_u32 v10, s53, v4
  s_mul_i32 s44, s54, 640
  s_add_u32 s44, s44, 10485760
  s_mov_b32 s55, 1.0
  s_and_b32 s53, s54, 511
  s_cmp_eq_u32 s53, 0
  s_cselect_b32 s55, 0.5, s55
  s_cmp_gt_u32 s54, 512
  s_cselect_b32 s55, 0, s55
  s_cselect_b32 s54, 0, s54
  s_lshl_b32 s72, s54, 11
  s_sub_u32 s73, 2048, s54
  s_and_b32 s73, s73, 2047
  s_lshl_b32 s73, s73, 11
  s_sub_u32 s74, 1024, s54
  s_lshl_b32 s74, s74, 11
  s_add_u32 s75, 1024, s54
  s_lshl_b32 s75, s75, 11
  v_lshlrev_b32 v128, 1, v10
  v_sub_u32 v6, 2048, v128
  v_and_b32 v6, 2047, v6
  v_sub_u32 v7, 1024, v128
  buffer_load_short_d16_hi v64, v128, s[20:23], s72 offen
  buffer_load_short_d16_hi v66, v6, s[20:23], s72 offen
  buffer_load_short_d16_hi v65, v7, s[20:23], s72 offen
  buffer_load_short_d16_hi v67, v128, s[20:23], s72 offen offset:1024
  buffer_load_short_d16_hi v68, v128, s[20:23], s73 offen
  buffer_load_short_d16_hi v70, v6, s[20:23], s73 offen
  buffer_load_short_d16_hi v69, v7, s[20:23], s73 offen
  buffer_load_short_d16_hi v71, v128, s[20:23], s73 offen offset:1024
  buffer_load_short_d16_hi v72, v128, s[20:23], s74 offen
  buffer_load_short_d16_hi v74, v6, s[20:23], s74 offen
  buffer_load_short_d16_hi v73, v7, s[20:23], s74 offen
  buffer_load_short_d16_hi v75, v128, s[20:23], s74 offen offset:1024
  buffer_load_short_d16_hi v76, v128, s[20:23], s75 offen
  buffer_load_short_d16_hi v78, v6, s[20:23], s75 offen
  buffer_load_short_d16_hi v77, v7, s[20:23], s75 offen
  buffer_load_short_d16_hi v79, v128, s[20:23], s75 offen offset:1024
  v_mov_b32 v152, s55
  v_and_b32 v1, 255, v10
  v_cmp_eq_u32 vcc, 0, v1
  v_mul_f32 v1, 0.5, v152
  s_nop 1
  v_cndmask_b32 v152, v152, v1, vcc
  v_cmp_lt_u32 vcc, 256, v10
  s_nop 1
  v_cndmask_b32 v152, v152, 0, vcc
  s_waitcnt vmcnt(0)
  v_pk_add_f32 v[2:3], v[64:65], v[68:69]
  v_pk_add_f32 v[6:7], v[64:65], v[68:69] neg_lo:[0,1] neg_hi:[0,1]
  v_pk_add_f32 v[8:9], v[72:73], v[76:77]
  v_pk_add_f32 v[10:11], v[72:73], v[76:77] neg_lo:[0,1] neg_hi:[0,1]
  v_pk_add_f32 v[64:65], v[2:3], v[8:9]
  v_pk_add_f32 v[68:69], v[2:3], v[8:9] neg_lo:[0,1] neg_hi:[0,1]
  v_pk_add_f32 v[72:73], v[6:7], v[10:11] neg_lo:[0,1] neg_hi:[0,1]
  v_pk_add_f32 v[76:77], v[6:7], v[10:11]
  v_pk_add_f32 v[2:3], v[66:67], v[70:71]
  v_pk_add_f32 v[6:7], v[66:67], v[70:71] neg_lo:[0,1] neg_hi:[0,1]
  v_pk_add_f32 v[8:9], v[74:75], v[78:79]
  v_pk_add_f32 v[10:11], v[74:75], v[78:79] neg_lo:[0,1] neg_hi:[0,1]
  v_pk_add_f32 v[66:67], v[2:3], v[8:9]
  v_pk_add_f32 v[70:71], v[2:3], v[8:9] neg_lo:[0,1] neg_hi:[0,1]
  v_pk_add_f32 v[74:75], v[6:7], v[10:11] neg_lo:[0,1] neg_hi:[0,1]
  v_pk_add_f32 v[78:79], v[6:7], v[10:11]
  v_pk_add_f32 v[2:3], v[64:65], v[66:67]
  v_pk_add_f32 v[6:7], v[2:3], v[2:3] op_sel:[0,1] op_sel_hi:[0,1] neg_hi:[0,1]
  v_pk_mul_f32 v[6:7], v[6:7], v[152:153] op_sel_hi:[1,0]
  v_cvt_pk_bf16_f32 v136, v6, v7
  s_add_u32 s53, s44, 0
  s_add_u32 s54, s44, 368640
  buffer_store_short v136, v128, s[32:35], s53 offen sc0 sc1
  buffer_store_short_d16_hi v136, v128, s[32:35], s54 offen sc0 sc1
  v_pk_add_f32 v[2:3], v[68:69], v[70:71]
  v_pk_add_f32 v[6:7], v[2:3], v[2:3] op_sel:[0,1] op_sel_hi:[0,1] neg_hi:[0,1]
  v_pk_mul_f32 v[6:7], v[6:7], v[152:153] op_sel_hi:[1,0]
  v_cvt_pk_bf16_f32 v137, v6, v7
  s_add_u32 s53, s44, 737280
  s_add_u32 s54, s44, 1105920
  buffer_store_short v137, v128, s[32:35], s53 offen sc0 sc1
  buffer_store_short_d16_hi v137, v128, s[32:35], s54 offen sc0 sc1
  v_pk_add_f32 v[2:3], v[72:73], v[74:75] neg_lo:[0,1] neg_hi:[0,1]
  v_pk_add_f32 v[6:7], v[2:3], v[2:3] op_sel:[0,1] op_sel_hi:[0,1] neg_lo:[0,1]
  v_pk_mul_f32 v[6:7], v[6:7], v[152:153] op_sel_hi:[1,0]
  v_cvt_pk_bf16_f32 v138, v6, v7
  s_add_u32 s53, s44, 1474560
  s_add_u32 s54, s44, 1843200
  buffer_store_short v138, v128, s[32:35], s53 offen sc0 sc1
  buffer_store_short_d16_hi v138, v128, s[32:35], s54 offen sc0 sc1
  v_pk_add_f32 v[2:3], v[76:77], v[78:79] neg_lo:[0,1] neg_hi:[0,1]
  v_pk_add_f32 v[6:7], v[2:3], v[2:3] op_sel:[0,1] op_sel_hi:[0,1] neg_lo:[0,1]
  v_pk_mul_f32 v[6:7], v[6:7], v[152:153] op_sel_hi:[1,0]
  v_cvt_pk_bf16_f32 v139, v6, v7
  s_add_u32 s53, s44, 2211840
  s_add_u32 s54, s44, 2580480
  buffer_store_short v139, v128, s[32:35], s53 offen sc0 sc1
  buffer_store_short_d16_hi v139, v128, s[32:35], s54 offen sc0 sc1
  s_add_u32 s47, s47, 1
  s_cmp_lt_u32 s47, 320
  s_cbranch_scc1 L_ffb_22
  s_waitcnt vmcnt(0)
  s_mov_b32 s54, s40
  s_mov_b32 s55, s41
  s_mov_b32 s20, s8
  s_mov_b32 s21, s9
  s_mov_b32 s22, 8388608
  s_mov_b32 s23, 0x20000
L_ok2_18:
  s_add_u32 m0, s56, 0
  s_add_u32 s64, s54, 0
  buffer_load_dwordx4 v12, s[32:35], s64 offen lds
  s_add_u32 m0, s56, 1024
  s_add_u32 s64, s54, 5120
  buffer_load_dwordx4 v13, s[32:35], s64 offen lds
  s_add_u32 m0, s56, 2048
  s_add_u32 s64, s54, 10240
  buffer_load_dwordx4 v12, s[32:35], s64 offen lds
  s_add_u32 m0, s56, 3072
  s_add_u32 s64, s54, 15360
  buffer_load_dwordx4 v13, s[32:35], s64 offen lds
  s_add_u32 m0, s56, 4096
  s_add_u32 s64, s54, 20480
  buffer_load_dwordx4 v12, s[32:35], s64 offen lds
  s_add_u32 m0, s56, 5120
  s_add_u32 s64, s54, 25600
  buffer_load_dwordx4 v13, s[32:35], s64 offen lds
  s_add_u32 m0, s56, 6144
  s_add_u32 s64, s54, 30720
  buffer_load_dwordx4 v12, s[32:35], s64 offen lds
  s_add_u32 m0, s56, 7168
  s_add_u32 s64, s54, 35840
  buffer_load_dwordx4 v13, s[32:35], s64 offen lds
  s_add_u32 m0, s56, 8192
  s_add_u32 s64, s55, 0
  buffer_load_dwordx4 v14, s[16:19], s64 offen lds
  s_add_u32 m0, s56, 9216
  s_add_u32 s64, s55, 32768
  buffer_load_dwordx4 v15, s[16:19], s64 offen lds
  s_add_u32 m0, s56, 10240
  s_add_u32 s64, s55, 65536
  buffer_load_dwordx4 v14, s[16:19], s64 offen lds
  s_add_u32 m0, s56, 11264
  s_add_u32 s64, s55, 98304
  buffer_load_dwordx4 v15, s[16:19], s64 offen lds
  s_add_u32 m0, s56, 12288
  s_add_u32 s64, s55, 131072
  buffer_load_dwordx4 v14, s[16:19], s64 offen lds
  s_add_u32 m0, s56, 13312
  s_add_u32 s64, s55, 163840
  buffer_load_dwordx4 v15, s[16:19], s64 offen lds
  s_add_u32 m0, s56, 14336
  s_add_u32 s64, s55, 196608
  buffer_load_dwordx4 v14, s[16:19], s64 offen lds
  s_add_u32 m0, s56, 15360
  s_add_u32 s64, s55, 229376
  buffer_load_dwordx4 v15, s[16:19], s64 offen lds
  s_add_u32 m0, s56, 16384
  s_add_u32 s64, s55, 262144
  buffer_load_dwordx4 v14, s[16:19], s64 offen lds
  s_add_u32 m0, s56, 17408
  s_add_u32 s64, s55, 294912
  buffer_load_dwordx4 v15, s[16:19], s64 offen lds
  s_add_u32 m0, s56, 18432
  s_add_u32 s64, s55, 327680
  buffer_load_dwordx4 v14, s[16:19], s64 offen lds
  s_add_u32 m0, s56, 19456
  s_add_u32 s64, s55, 360448
  buffer_load_dwordx4 v15, s[16:19], s64 offen lds
  s_add_u32 s54, s54, 128
  s_add_u32 s55, s55, 128
  s_add_u32 s56, s56, 20480
  s_mov_b32 s47, 0
L_ld1_23:
  s_waitcnt vmcnt(20)
  s_barrier
  s_add_u32 m0, s46, 0
  s_add_u32 s64, s45, 0
  buffer_load_dwordx4 v5, s[36:39], s64 offen lds
  s_add_u32 m0, s46, 1024
  s_add_u32 s64, s45, 1024
  buffer_load_dwordx4 v5, s[36:39], s64 offen lds
  s_add_u32 m0, s46, 2048
  s_add_u32 s64, s45, 2048
  buffer_load_dwordx4 v5, s[36:39], s64 offen lds
  s_add_u32 m0, s46, 3072
  s_add_u32 s64, s45, 3072
  buffer_load_dwordx4 v5, s[36:39], s64 offen lds
  s_add_u32 m0, s46, 4096
  s_add_u32 s64, s45, 4096
  buffer_load_dwordx4 v5, s[36:39], s64 offen lds
  s_add_u32 m0, s46, 5120
  s_add_u32 s64, s45, 5120
  buffer_load_dwordx4 v5, s[36:39], s64 offen lds
  s_add_u32 m0, s46, 6144
  s_add_u32 s64, s45, 6144
  buffer_load_dwordx4 v5, s[36:39], s64 offen lds
  s_add_u32 m0, s46, 7168
  s_add_u32 s64, s45, 7168
  buffer_load_dwordx4 v5, s[36:39], s64 offen lds
  s_add_u32 m0, s46, 8192
  s_add_u32 s64, s45, 8192
  buffer_load_dwordx4 v5, s[36:39], s64 offen lds
  s_add_u32 m0, s46, 9216
  s_add_u32 s64, s45, 9216
  buffer_load_dwordx4 v5, s[36:39], s64 offen lds
  s_add_u32 m0, s46, 10240
  s_add_u32 s64, s45, 10240
  buffer_load_dwordx4 v5, s[36:39], s64 offen lds
  s_add_u32 m0, s46, 11264
  s_add_u32 s64, s45, 11264
  buffer_load_dwordx4 v5, s[36:39], s64 offen lds
  s_add_u32 m0, s46, 12288
  s_add_u32 s64, s45, 12288
  buffer_load_dwordx4 v5, s[36:39], s64 offen lds
  s_add_u32 m0, s46, 13312
  s_add_u32 s64, s45, 13312
  buffer_load_dwordx4 v5, s[36:39], s64 offen lds
  s_add_u32 m0, s46, 14336
  s_add_u32 s64, s45, 14336
  buffer_load_dwordx4 v5, s[36:39], s64 offen lds
  s_add_u32 m0, s46, 15360
  s_add_u32 s64, s45, 15360
  buffer_load_dwordx4 v5, s[36:39], s64 offen lds
  s_add_u32 s45, s45, 16384
  s_add_u32 s46, s46, 16384
  s_cmp_eq_u32 s46, 49152
  s_cselect_b32 s46, 0, s46
  s_add_u32 m0, s56, 0
  s_add_u32 s64, s54, 0
  buffer_load_dwordx4 v12, s[32:35], s64 offen lds
  s_add_u32 m0, s56, 1024
  s_add_u32 s64, s54, 5120
  buffer_load_dwordx4 v13, s[32:35], s64 offen lds
  s_add_u32 m0, s56, 2048
  s_add_u32 s64, s54, 10240
  buffer_load_dwordx4 v12, s[32:35], s64 offen lds
  s_add_u32 m0, s56, 3072
  s_add_u32 s64, s54, 15360
  buffer_load_dwordx4 v13, s[32:35], s64 offen lds
  s_add_u32 m0, s56, 4096
  s_add_u32 s64, s54, 20480
  buffer_load_dwordx4 v12, s[32:35], s64 offen lds
  s_add_u32 m0, s56, 5120
  s_add_u32 s64, s54, 25600
  buffer_load_dwordx4 v13, s[32:35], s64 offen lds
  s_add_u32 m0, s56, 6144
  s_add_u32 s64, s54, 30720
  buffer_load_dwordx4 v12, s[32:35], s64 offen lds
  s_add_u32 m0, s56, 7168
  s_add_u32 s64, s54, 35840
  buffer_load_dwordx4 v13, s[32:35], s64 offen lds
  s_add_u32 m0, s56, 8192
  s_add_u32 s64, s55, 0
  buffer_load_dwordx4 v14, s[16:19], s64 offen lds
  s_add_u32 m0, s56, 9216
  s_add_u32 s64, s55, 32768
  buffer_load_dwordx4 v15, s[16:19], s64 offen lds
  s_add_u32 m0, s56, 10240
  s_add_u32 s64, s55, 65536
  buffer_load_dwordx4 v14, s[16:19], s64 offen lds
  s_add_u32 m0, s56, 11264
  s_add_u32 s64, s55, 98304
  buffer_load_dwordx4 v15, s[16:19], s64 offen lds
  s_add_u32 m0, s56, 12288
  s_add_u32 s64, s55, 131072
  buffer_load_dwordx4 v14, s[16:19], s64 offen lds
  s_add_u32 m0, s56, 13312
  s_add_u32 s64, s55, 163840
  buffer_load_dwordx4 v15, s[16:19], s64 offen lds
  s_add_u32 m0, s56, 14336
  s_add_u32 s64, s55, 196608
  buffer_load_dwordx4 v14, s[16:19], s64 offen lds
  s_add_u32 m0, s56, 15360
  s_add_u32 s64, s55, 229376
  buffer_load_dwordx4 v15, s[16:19], s64 offen lds
  s_add_u32 m0, s56, 16384
  s_add_u32 s64, s55, 262144
  buffer_load_dwordx4 v14, s[16:19], s64 offen lds
  s_add_u32 m0, s56, 17408
  s_add_u32 s64, s55, 294912
  buffer_load_dwordx4 v15, s[16:19], s64 offen lds
  s_add_u32 m0, s56, 18432
  s_add_u32 s64, s55, 327680
  buffer_load_dwordx4 v14, s[16:19], s64 offen lds
  s_add_u32 m0, s56, 19456
  s_add_u32 s64, s55, 360448
  buffer_load_dwordx4 v15, s[16:19], s64 offen lds
  s_add_u32 s54, s54, 128
  s_add_u32 s55, s55, 128
  s_add_u32 s56, s56, 20480
  s_add_u32 s47, s47, 1
  s_cmp_lt_u32 s47, 4
  s_cbranch_scc1 L_ld1_23
  s_waitcnt vmcnt(20)
  s_barrier
  buffer_load_dword v21, v17, s[20:23], s57 offen
  buffer_load_dword v22, v17, s[24:27], s57 offen
  buffer_load_dword v21, v18, s[20:23], s57 offen
  buffer_load_dword v22, v18, s[24:27], s57 offen
  s_waitcnt vmcnt(4)
  s_barrier
  s_branch L_end_1
L_comp_2:
  s_add_u32 s3, s2, s42
  s_cmp_eq_u32 s3, 0
  s_cselect_b32 s30, -1, 0
  s_mov_b32 s31, 0
  v_mov_b32 v60, 0
  v_mov_b32 v61, 0
  v_mov_b32 v62, 0
  v_mov_b32 v63, 0
  v_lshlrev_b32 v1, 7, v4
  s_mov_b64 exec, s[30:31]
  buffer_store_dwordx4 v[60:63], v1, s[32:35], 0 offen sc0 sc1
  s_mov_b64 exec, -1
  s_mov_b32 s16, s96
  s_mov_b32 s17, s97
  s_mov_b32 s18, 4194304
  s_mov_b32 s19, 0x20000
  s_bitcmp1_b32 s66, 0
  s_cselect_b32 s20, s58, s56
  s_cselect_b32 s21, s59, s57
  s_mov_b32 s22, 65536
  s_mov_b32 s23, 0x20000
  s_lshl_b32 s45, s42, 13
  s_cmp_ge_u32 s42, 6
  s_cselect_b32 s40, 98304, 0
  s_add_u32 s40, s40, s45
  s_add_u32 m0, s40, 0
  s_add_u32 s64, s45, 0
  buffer_load_dwordx4 v5, s[20:23], s64 offen lds
  s_add_u32 m0, s40, 1024
  s_add_u32 s64, s45, 1024
  buffer_load_dwordx4 v5, s[20:23], s64 offen lds
  s_add_u32 m0, s40, 2048
  s_add_u32 s64, s45, 2048
  buffer_load_dwordx4 v5, s[20:23], s64 offen lds
  s_add_u32 m0, s40, 3072
  s_add_u32 s64, s45, 3072
  buffer_load_dwordx4 v5, s[20:23], s64 offen lds
  s_add_u32 m0, s40, 4096
  s_add_u32 s64, s45, 4096
  buffer_load_dwordx4 v5, s[20:23], s64 offen lds
  s_add_u32 m0, s40, 5120
  s_add_u32 s64, s45, 5120
  buffer_load_dwordx4 v5, s[20:23], s64 offen lds
  s_add_u32 m0, s40, 6144
  s_add_u32 s64, s45, 6144
  buffer_load_dwordx4 v5, s[20:23], s64 offen lds
  s_add_u32 m0, s40, 7168
  s_add_u32 s64, s45, 7168
  buffer_load_dwordx4 v5, s[20:23], s64 offen lds
  s_lshl_b32 s46, s65, 4
  s_lshr_b32 s64, s66, 1
  s_add_u32 s46, s46, s64
  s_lshl_b32 s45, s46, 15
  s_lshl_b32 s64, s42, 8
  s_add_u32 s45, s45, s64
  v_and_b32 v1, 15, v4
  v_lshrrev_b32 v2, 4, v4
  v_lshlrev_b32 v3, 4, v2
  v_lshl_add_u32 v3, v1, 11, v3
  buffer_load_dwordx4 v[64:67], v3, s[16:19], s45 offen offset:0
  buffer_load_dwordx4 v[68:71], v3, s[16:19], s45 offen offset:64
  buffer_load_dwordx4 v[72:75], v3, s[16:19], s45 offen offset:128
  buffer_load_dwordx4 v[76:79], v3, s[16:19], s45 offen offset:192
  v_and_b32 v3, 1, v2
  v_lshl_add_u32 v3, v3, 5, v1
  v_lshlrev_b32 v3, 4, v3
  v_lshrrev_b32 v8, 1, v2
  v_lshl_add_u32 v8, v8, 3, v3
  v_bfe_u32 v1, v4, 2, 2
  v_lshl_add_u32 v1, v2, 3, v1
  v_lshlrev_b32 v1, 6, v1
  v_and_b32 v2, 3, v4
  v_lshl_add_u32 v1, v2, 3, v1
  v_add_u32 v9, s40, v1
  s_lshr_b32 s41, s46, 1
  s_lshl_b32 s41, s41, 12
  s_add_u32 s41, s41, 4194304
  s_and_b32 s46, s46, 1
  s_bitcmp1_b32 s66, 0
  s_cselect_b32 s45, 10, 8
  s_cselect_b32 s49, 1, 4
  s_cselect_b32 s64, 2048, 0
  s_add_u32 s41, s41, s64
  s_lshl_b32 s46, s46, s45
  s_add_u32 s41, s41, s46
  s_lshl_b32 s49, s49, 8
  s_add_u32 s49, s49, s41
  s_mov_b32 s24, s98
  s_mov_b32 s25, s99
  s_mov_b32 s26, 2097152
  s_mov_b32 s27, 0x20000
  v_lshrrev_b32 v1, 1, v4
  v_and_b32 v2, 1, v4
  v_lshlrev_b32 v2, 6, v2
  v_lshl_add_u32 v10, v1, 11, v2
  s_lshr_b32 s53, s66, 4
  s_lshl_b32 s53, s53, 3
  s_add_u32 s53, s53, s66
  s_add_u32 s53, s53, 4
  s_lshl_b32 s53, s53, 1
  s_add_u32 s53, s53, s42
  s_and_b32 s53, s53, 31
  s_lshl_b32 s53, s53, 16
  s_and_b32 s54, s66, 15
  s_lshl_b32 s54, s54, 7
  s_add_u32 s53, s53, s54
  s_waitcnt vmcnt(0)
  buffer_load_dword v56, v10, s[24:27], s53 offen
  s_and_b32 s30, s30, 1
  v_mov_b32 v1, 0
  v_mov_b32 v2, 1
  s_mov_b64 exec, s[30:31]
  global_store_dword v1, v2, s[62:63] sc0 sc1
  s_mov_b64 exec, -1
  ds_read_b64_tr_b16 v[80:81], v9 offset:0
  ds_read_b64_tr_b16 v[82:83], v9 offset:256
  ds_read_b64_tr_b16 v[84:85], v9 offset:32
  ds_read_b64_tr_b16 v[86:87], v9 offset:288
  ds_read_b64_tr_b16 v[88:89], v9 offset:2048
  ds_read_b64_tr_b16 v[90:91], v9 offset:2304
  ds_read_b64_tr_b16 v[92:93], v9 offset:2080
  ds_read_b64_tr_b16 v[94:95], v9 offset:2336
  s_waitcnt lgkmcnt(4)
  ds_read_b64_tr_b16 v[96:97], v9 offset:4096
  ds_read_b64_tr_b16 v[98:99], v9 offset:4352
  ds_read_b64_tr_b16 v[100:101], v9 offset:4128
  ds_read_b64_tr_b16 v[102:103], v9 offset:4384
  ds_read_b64_tr_b16 v[104:105], v9 offset:6144
  ds_read_b64_tr_b16 v[106:107], v9 offset:6400
  ds_read_b64_tr_b16 v[108:109], v9 offset:6176
  ds_read_b64_tr_b16 v[110:111], v9 offset:6432
  s_waitcnt lgkmcnt(0)
  s_bitcmp1_b32 s66, 0
  s_cbranch_scc1 L_kvv_24
  v_mfma_f32_16x16x32_bf16 v[112:115], v[80:83], v[64:67], 0
  v_mfma_f32_16x16x32_bf16 v[116:119], v[84:87], v[64:67], 0
  v_mfma_f32_16x16x32_bf16 v[112:115], v[88:91], v[68:71], v[112:115]
  v_mfma_f32_16x16x32_bf16 v[116:119], v[92:95], v[68:71], v[116:119]
  v_mfma_f32_16x16x32_bf16 v[112:115], v[96:99], v[72:75], v[112:115]
  v_mfma_f32_16x16x32_bf16 v[116:119], v[100:103], v[72:75], v[116:119]
  v_mfma_f32_16x16x32_bf16 v[112:115], v[104:107], v[76:79], v[112:115]
  v_mfma_f32_16x16x32_bf16 v[116:119], v[108:111], v[76:79], v[116:119]
  s_branch L_kvj_25
L_kvv_24:
  v_mfma_f32_16x16x32_bf16 v[112:115], v[64:67], v[80:83], 0
  v_mfma_f32_16x16x32_bf16 v[116:119], v[64:67], v[84:87], 0
  v_mfma_f32_16x16x32_bf16 v[112:115], v[68:71], v[88:91], v[112:115]
  v_mfma_f32_16x16x32_bf16 v[116:119], v[68:71], v[92:95], v[116:119]
  v_mfma_f32_16x16x32_bf16 v[112:115], v[72:75], v[96:99], v[112:115]
  v_mfma_f32_16x16x32_bf16 v[116:119], v[72:75], v[100:103], v[116:119]
  v_mfma_f32_16x16x32_bf16 v[112:115], v[76:79], v[104:107], v[112:115]
  v_mfma_f32_16x16x32_bf16 v[116:119], v[76:79], v[108:111], v[116:119]
L_kvj_25:
  v_add_u32 v9, s40, v5
  s_nop 15
  ds_write_b128 v9, v[112:115] offset:0
  ds_write_b128 v9, v[116:119] offset:1024
  s_waitcnt lgkmcnt(0)
  s_barrier
  s_cmp_lt_u32 s42, 7
  s_cbranch_scc1 L_kvn_26
  v_add_u32 v10, 147456, v5
  ds_read_b128 v[64:67], v5 offset:0
  ds_read_b128 v[68:71], v5 offset:8192
  ds_read_b128 v[72:75], v5 offset:16384
  ds_read_b128 v[76:79], v5 offset:24576
  ds_read_b128 v[80:83], v5 offset:32768
  ds_read_b128 v[84:87], v5 offset:40960
  ds_read_b128 v[88:91], v10 offset:0
  ds_read_b128 v[92:95], v10 offset:8192
  s_waitcnt lgkmcnt(6)
  v_add_f32 v64, v64, v68
  v_add_f32 v65, v65, v69
  v_add_f32 v66, v66, v70
  v_add_f32 v67, v67, v71
  s_waitcnt lgkmcnt(5)
  v_add_f32 v64, v64, v72
  v_add_f32 v65, v65, v73
  v_add_f32 v66, v66, v74
  v_add_f32 v67, v67, v75
  s_waitcnt lgkmcnt(4)
  v_add_f32 v64, v64, v76
  v_add_f32 v65, v65, v77
  v_add_f32 v66, v66, v78
  v_add_f32 v67, v67, v79
  s_waitcnt lgkmcnt(3)
  v_add_f32 v64, v64, v80
  v_add_f32 v65, v65, v81
  v_add_f32 v66, v66, v82
  v_add_f32 v67, v67, v83
  s_waitcnt lgkmcnt(2)
  v_add_f32 v64, v64, v84
  v_add_f32 v65, v65, v85
  v_add_f32 v66, v66, v86
  v_add_f32 v67, v67, v87
  s_waitcnt lgkmcnt(1)
  v_add_f32 v64, v64, v88
  v_add_f32 v65, v65, v89
  v_add_f32 v66, v66, v90
  v_add_f32 v67, v67, v91
  s_waitcnt lgkmcnt(0)
  v_add_f32 v64, v64, v92
  v_add_f32 v65, v65, v93
  v_add_f32 v66, v66, v94
  v_add_f32 v67, v67, v95
  v_cvt_pk_bf16_f32 v58, v64, v65
  v_cvt_pk_bf16_f32 v59, v66, v67
  buffer_store_dwordx2 v[58:59], v8, s[32:35], s41 offen sc0 sc1
  ds_read_b128 v[96:99], v5 offset:1024
  ds_read_b128 v[100:103], v5 offset:9216
  ds_read_b128 v[104:107], v5 offset:17408
  ds_read_b128 v[108:111], v5 offset:25600
  ds_read_b128 v[112:115], v5 offset:33792
  ds_read_b128 v[116:119], v5 offset:41984
  ds_read_b128 v[120:123], v10 offset:1024
  ds_read_b128 v[124:127], v10 offset:9216
  s_waitcnt lgkmcnt(6)
  v_add_f32 v96, v96, v100
  v_add_f32 v97, v97, v101
  v_add_f32 v98, v98, v102
  v_add_f32 v99, v99, v103
  s_waitcnt lgkmcnt(5)
  v_add_f32 v96, v96, v104
  v_add_f32 v97, v97, v105
  v_add_f32 v98, v98, v106
  v_add_f32 v99, v99, v107
  s_waitcnt lgkmcnt(4)
  v_add_f32 v96, v96, v108
  v_add_f32 v97, v97, v109
  v_add_f32 v98, v98, v110
  v_add_f32 v99, v99, v111
  s_waitcnt lgkmcnt(3)
  v_add_f32 v96, v96, v112
  v_add_f32 v97, v97, v113
  v_add_f32 v98, v98, v114
  v_add_f32 v99, v99, v115
  s_waitcnt lgkmcnt(2)
  v_add_f32 v96, v96, v116
  v_add_f32 v97, v97, v117
  v_add_f32 v98, v98, v118
  v_add_f32 v99, v99, v119
  s_waitcnt lgkmcnt(1)
  v_add_f32 v96, v96, v120
  v_add_f32 v97, v97, v121
  v_add_f32 v98, v98, v122
  v_add_f32 v99, v99, v123
  s_waitcnt lgkmcnt(0)
  v_add_f32 v96, v96, v124
  v_add_f32 v97, v97, v125
  v_add_f32 v98, v98, v126
  v_add_f32 v99, v99, v127
  v_cvt_pk_bf16_f32 v60, v96, v97
  v_cvt_pk_bf16_f32 v61, v98, v99
  buffer_store_dwordx2 v[60:61], v8, s[32:35], s49 offen sc0 sc1
L_kvn_26:
  v_bfe_u32 v1, v4, 1, 3
  v_lshrrev_b32 v2, 5, v4
  v_xor_b32 v1, v1, v2
  v_lshlrev_b32 v1, 4, v1
  v_and_b32 v2, 31, v4
  v_lshl_add_u32 v6, v2, 7, v1
  s_lshl_b32 s64, s69, 12
  s_add_u32 s64, s64, 49152
  v_add_u32 v6, s64, v6
  v_xor_b32 v128, 0, v6
  v_xor_b32 v129, 32, v6
  v_xor_b32 v130, 64, v6
  v_xor_b32 v131, 96, v6
  v_bfe_u32 v1, v4, 2, 2
  v_lshrrev_b32 v2, 5, v4
  v_lshl_add_u32 v2, v2, 3, v1
  v_lshlrev_b32 v2, 7, v2
  v_lshrrev_b32 v1, 1, v1
  v_xor_b32 v1, s70, v1
  v_lshl_add_u32 v2, v1, 6, v2
  v_bfe_u32 v1, v4, 4, 1
  v_lshl_add_u32 v2, v1, 5, v2
  v_and_b32 v1, 3, v4
  v_lshl_add_u32 v132, v1, 3, v2
  v_add_u32 v132, 49152, v132
  s_mov_b32 s47, 0
  s_cmp_eq_u32 s42, 7
  s_cselect_b32 s48, 0, 99
  v_mov_b32 v96, 0
  v_mov_b32 v97, 0
  v_mov_b32 v98, 0
  v_mov_b32 v99, 0
  v_mov_b32 v100, 0
  v_mov_b32 v101, 0
  v_mov_b32 v102, 0
  v_mov_b32 v103, 0
  v_mov_b32 v104, 0
  v_mov_b32 v105, 0
  v_mov_b32 v106, 0
  v_mov_b32 v107, 0
  v_mov_b32 v108, 0
  v_mov_b32 v109, 0
  v_mov_b32 v110, 0
  v_mov_b32 v111, 0
  s_mov_b32 s72, 0
  v_add_u32 v133, s72, v128
  v_add_u32 v134, s72, v129
  v_add_u32 v135, s72, v130
  v_add_u32 v136, s72, v131
  v_add_u32 v137, s72, v132
  s_mov_b32 s73, 0
  s_barrier
  ds_read_b128 v[64:67], v133 offset:0
  ds_read_b64_tr_b16 v[68:69], v137 offset:16384
  ds_read_b64_tr_b16 v[70:71], v137 offset:16896
  ds_read_b128 v[72:75], v134 offset:0
  ds_read_b64_tr_b16 v[76:77], v137 offset:18432
  ds_read_b64_tr_b16 v[78:79], v137 offset:18944
  ds_read_b128 v[80:83], v135 offset:0
  ds_read_b64_tr_b16 v[84:85], v137 offset:20480
  ds_read_b64_tr_b16 v[86:87], v137 offset:20992
L_gl_27:
  s_add_u32 s72, s72, 24576
  s_cmp_eq_u32 s72, 98304
  s_cselect_b32 s72, 0, s72
  s_cmp_eq_u32 s73, 15
  s_cbranch_scc1 L_gnb_28
  s_barrier
  s_cmp_lt_u32 s73, s48
  s_cbranch_scc1 L_nfx_29
  s_cbranch_scc0 L_nfy_30
L_nfy_30:
  s_cmp_eq_u32 s47, 0
  s_mov_b32 s47, 1
  s_cbranch_scc1 L_nfz_31
  s_waitcnt vmcnt(0)
  v_readfirstlane_b32 s3, v56
  s_cmp_lg_u32 s3, 1
  s_cbranch_scc1 L_nfz_31
  s_and_b32 s3, s2, 15
  s_lshl_b32 s3, s3, 7
  s_lshr_b32 s64, s2, 4
  s_add_u32 s3, s3, s64
  v_mov_b32 v1, s3
  v_mov_b32 v2, 1
  s_mov_b64 exec, 1
  buffer_store_byte v2, v1, s[32:35], 0 offen offset:0 sc0 sc1
  s_mov_b64 exec, -1
  s_mov_b32 s48, 99
  s_branch L_nfx_29
L_nfz_31:
  v_mov_b32 v57, 0
  global_load_dword v56, v57, s[62:63] sc0 sc1
  s_add_u32 s48, s73, 3
L_nfx_29:
L_gnb_28:
  s_waitcnt lgkmcnt(6)
  v_mfma_f32_32x32x16_bf16 v[96:111], v[68:71], v[64:67], v[96:111]
  ds_read_b128 v[88:91], v136 offset:0
  ds_read_b64_tr_b16 v[92:93], v137 offset:22528
  ds_read_b64_tr_b16 v[94:95], v137 offset:23040
  v_add_u32 v133, s72, v128
  v_add_u32 v134, s72, v129
  v_add_u32 v135, s72, v130
  v_add_u32 v136, s72, v131
  v_add_u32 v137, s72, v132
  s_waitcnt lgkmcnt(6)
  v_mfma_f32_32x32x16_bf16 v[96:111], v[76:79], v[72:75], v[96:111]
  ds_read_b128 v[64:67], v133 offset:0
  ds_read_b64_tr_b16 v[68:69], v137 offset:16384
  ds_read_b64_tr_b16 v[70:71], v137 offset:16896
  s_waitcnt lgkmcnt(6)
  v_mfma_f32_32x32x16_bf16 v[96:111], v[84:87], v[80:83], v[96:111]
  ds_read_b128 v[72:75], v134 offset:0
  ds_read_b64_tr_b16 v[76:77], v137 offset:18432
  ds_read_b64_tr_b16 v[78:79], v137 offset:18944
  s_waitcnt lgkmcnt(6)
  v_mfma_f32_32x32x16_bf16 v[96:111], v[92:95], v[88:91], v[96:111]
  ds_read_b128 v[80:83], v135 offset:0
  ds_read_b64_tr_b16 v[84:85], v137 offset:20480
  ds_read_b64_tr_b16 v[86:87], v137 offset:20992
  s_add_u32 s73, s73, 1
  s_cmp_lt_u32 s73, 16
  s_cbranch_scc1 L_gl_27
  s_waitcnt lgkmcnt(0)
  s_mov_b32 s64, 0x3e8293ee
  s_nop 9
  v_mul_f32 v96, s64, v96
  v_mul_f32 v97, s64, v97
  v_mul_f32 v98, s64, v98
  v_mul_f32 v99, s64, v99
  v_mul_f32 v100, s64, v100
  v_mul_f32 v101, s64, v101
  v_mul_f32 v102, s64, v102
  v_mul_f32 v103, s64, v103
  v_mul_f32 v104, s64, v104
  v_mul_f32 v105, s64, v105
  v_mul_f32 v106, s64, v106
  v_mul_f32 v107, s64, v107
  v_mul_f32 v108, s64, v108
  v_mul_f32 v109, s64, v109
  v_mul_f32 v110, s64, v110
  v_mul_f32 v111, s64, v111
  v_cvt_pk_bf16_f32 v12, v96, v97
  v_cvt_pk_bf16_f32 v13, v98, v99
  v_cvt_pk_bf16_f32 v14, v100, v101
  v_cvt_pk_bf16_f32 v15, v102, v103
  v_cvt_pk_bf16_f32 v16, v104, v105
  v_cvt_pk_bf16_f32 v17, v106, v107
  v_cvt_pk_bf16_f32 v18, v108, v109
  v_cvt_pk_bf16_f32 v19, v110, v111
L_init_32:
  v_add_u32 v6, 32768, v5
  v_mov_b32 v7, v5
  v_add_u32 v8, 16384, v5
  v_mov_b32 v10, 0
  v_mov_b32 v112, 0
  v_mov_b32 v113, 0
  v_mov_b32 v114, 0
  v_mov_b32 v115, 0
  v_mov_b32 v116, 0
  v_mov_b32 v117, 0
  v_mov_b32 v118, 0
  v_mov_b32 v119, 0
  v_mov_b32 v120, 0
  v_mov_b32 v121, 0
  v_mov_b32 v122, 0
  v_mov_b32 v123, 0
  v_mov_b32 v124, 0
  v_mov_b32 v125, 0
  v_mov_b32 v126, 0
  v_mov_b32 v127, 0
  v_mov_b32 v52, 0
  v_mov_b32 v36, 0
  v_mov_b32 v53, 0
  v_mov_b32 v37, 0
  v_mov_b32 v54, 0
  v_mov_b32 v38, 0
  v_mov_b32 v55, 0
  v_mov_b32 v39, 0
  v_mov_b32 v56, 0
  v_mov_b32 v40, 0
  v_mov_b32 v57, 0
  v_mov_b32 v41, 0
  v_mov_b32 v58, 0
  v_mov_b32 v42, 0
  v_mov_b32 v59, 0
  v_mov_b32 v43, 0
  v_mov_b32 v24, 0
  v_mov_b32 v25, 0
  v_mov_b32 v26, 0
  v_mov_b32 v27, 0
  v_bfe_u32 v1, v4, 4, 1
  v_bfe_u32 v2, v4, 2, 1
  v_cmp_eq_u32 vcc, v1, v2
  v_mov_b32 v1, 0x3f803f80
  s_nop 1
  v_cndmask_b32 v20, 0, v1, vcc
  v_cndmask_b32 v21, 0, v1, vcc
  v_cndmask_b32 v22, 0, v1, vcc
  v_cndmask_b32 v23, 0, v1, vcc
  s_mov_b32 s48, 0x6f800000
  s_waitcnt vmcnt(0)
  s_barrier
  ds_read_b128 v[28:31], v7
  ds_read_b128 v[32:35], v7 offset:1024
  v_mov_b32 v1, 163824
  ds_read_b32 v2, v1
  s_waitcnt lgkmcnt(0)
  v_readfirstlane_b32 s3, v2
  s_cmp_lg_u32 s3, 0
  s_cbranch_scc1 L_fb_33
  v_mfma_f32_32x32x16_bf16 v[80:95], v[28:31], v[12:15], 0
  v_mfma_f32_32x32x16_bf16 v[80:95], v[32:35], v[16:19], v[80:95]
  ds_read_b128 v[28:31], v7 offset:4096
  ds_read_b128 v[32:35], v7 offset:5120
  s_mov_b32 s47, 0
  s_nop 11
  v_max3_f32 v1, v80, v81, v82
  v_max3_f32 v1, v1, v83, v84
  v_max3_f32 v1, v1, v85, v86
  v_max3_f32 v1, v1, v87, v88
  v_max3_f32 v1, v1, v89, v90
  v_max3_f32 v1, v1, v91, v92
  v_max3_f32 v1, v1, v93, v94
  v_max_f32 v1, v1, v95
  v_mov_b32 v2, v1
  s_nop 1
  v_permlane32_swap_b32 v1, v2
  s_nop 1
  v_max_f32 v1, v1, v2
  v_add_f32 v1, 0x42b40000, v1
  v_mov_b32 v9, v1
  v_sub_f32 v3, 0, v1
  v_mov_b32 v64, v3
  v_sub_f32 v80, v80, v1
  v_mov_b32 v65, v3
  v_sub_f32 v81, v81, v1
  v_mov_b32 v66, v3
  v_sub_f32 v82, v82, v1
  v_mov_b32 v67, v3
  v_sub_f32 v83, v83, v1
  v_mov_b32 v68, v3
  v_sub_f32 v84, v84, v1
  v_mov_b32 v69, v3
  v_sub_f32 v85, v85, v1
  v_mov_b32 v70, v3
  v_sub_f32 v86, v86, v1
  v_mov_b32 v71, v3
  v_sub_f32 v87, v87, v1
  v_mov_b32 v72, v3
  v_sub_f32 v88, v88, v1
  v_mov_b32 v73, v3
  v_sub_f32 v89, v89, v1
  v_mov_b32 v74, v3
  v_sub_f32 v90, v90, v1
  v_mov_b32 v75, v3
  v_sub_f32 v91, v91, v1
  v_mov_b32 v76, v3
  v_sub_f32 v92, v92, v1
  v_mov_b32 v77, v3
  v_sub_f32 v93, v93, v1
  v_mov_b32 v78, v3
  v_sub_f32 v94, v94, v1
  v_mov_b32 v79, v3
  v_sub_f32 v95, v95, v1
  s_waitcnt lgkmcnt(0)
L_loop_34:
  s_setprio 1
  s_waitcnt lgkmcnt(2)
  v_mfma_f32_32x32x16_bf16 v[96:111], v[28:31], v[12:15], v[64:79]
  v_exp_f32 v80, v80
  v_exp_f32 v81, v81
  v_exp_f32 v82, v82
  v_mfma_f32_16x16x32_bf16 v[24:27], v[20:23], v[56:59], v[24:27]
  v_exp_f32 v83, v83
  v_cvt_pk_bf16_f32 v44, v80, v81
  v_exp_f32 v84, v84
  v_mfma_f32_32x32x16_bf16 v[96:111], v[32:35], v[16:19], v[96:111]
  v_exp_f32 v85, v85
  v_cvt_pk_bf16_f32 v45, v82, v83
  v_exp_f32 v86, v86
  v_exp_f32 v87, v87
  v_cmp_nge_f32 vcc, s48, v24
  ds_read_b128 v[28:31], v7 offset:8192
  v_cvt_pk_bf16_f32 v46, v84, v85
  ds_read_b128 v[32:35], v7 offset:9216
  s_waitcnt lgkmcnt(2)
  s_cbranch_vccnz L_slow_35
L_ret_36:
  v_mfma_f32_32x32x16_bf16 v[112:127], v[36:39], v[52:55], v[112:127]
  v_add_f32 v10, v10, v24
  v_exp_f32 v88, v88
  v_exp_f32 v89, v89
  v_cvt_pk_bf16_f32 v47, v86, v87
  v_exp_f32 v90, v90
  v_mfma_f32_32x32x16_bf16 v[112:127], v[40:43], v[56:59], v[112:127]
  v_exp_f32 v91, v91
  v_cvt_pk_bf16_f32 v48, v88, v89
  v_exp_f32 v92, v92
  v_exp_f32 v93, v93
  v_mfma_f32_16x16x32_bf16 v[24:27], v[20:23], v[44:47], 0
  ds_read_b128 v[36:39], v7 offset:2048
  v_cvt_pk_bf16_f32 v49, v90, v91
  ds_read_b128 v[40:43], v7 offset:3072
  v_exp_f32 v94, v94
  v_exp_f32 v95, v95
  v_cvt_pk_bf16_f32 v50, v92, v93
  v_cvt_pk_bf16_f32 v51, v94, v95
  s_setprio 0
  s_waitcnt lgkmcnt(2)
  v_mfma_f32_32x32x16_bf16 v[80:95], v[28:31], v[12:15], v[64:79]
  v_exp_f32 v96, v96
  v_exp_f32 v97, v97
  v_exp_f32 v98, v98
  v_mfma_f32_16x16x32_bf16 v[24:27], v[20:23], v[48:51], v[24:27]
  v_exp_f32 v99, v99
  v_cvt_pk_bf16_f32 v52, v96, v97
  v_exp_f32 v100, v100
  v_mfma_f32_32x32x16_bf16 v[80:95], v[32:35], v[16:19], v[80:95]
  v_exp_f32 v101, v101
  v_cvt_pk_bf16_f32 v53, v98, v99
  v_exp_f32 v102, v102
  v_exp_f32 v103, v103
  v_cmp_nge_f32 vcc, s48, v24
  ds_read_b128 v[28:31], v7 offset:12288
  v_cvt_pk_bf16_f32 v54, v100, v101
  ds_read_b128 v[32:35], v7 offset:13312
  s_waitcnt lgkmcnt(2)
  s_cbranch_vccnz L_slow_37
L_ret_38:
  v_mfma_f32_32x32x16_bf16 v[112:127], v[36:39], v[44:47], v[112:127]
  v_add_f32 v10, v10, v24
  v_exp_f32 v104, v104
  v_exp_f32 v105, v105
  v_cvt_pk_bf16_f32 v55, v102, v103
  v_exp_f32 v106, v106
  v_mfma_f32_32x32x16_bf16 v[112:127], v[40:43], v[48:51], v[112:127]
  v_exp_f32 v107, v107
  v_cvt_pk_bf16_f32 v56, v104, v105
  v_exp_f32 v108, v108
  v_exp_f32 v109, v109
  v_mfma_f32_16x16x32_bf16 v[24:27], v[20:23], v[52:55], 0
  ds_read_b128 v[36:39], v7 offset:6144
  v_cvt_pk_bf16_f32 v57, v106, v107
  ds_read_b128 v[40:43], v7 offset:7168
  v_exp_f32 v110, v110
  v_exp_f32 v111, v111
  v_cvt_pk_bf16_f32 v58, v108, v109
  v_cvt_pk_bf16_f32 v59, v110, v111
  s_barrier
  s_setprio 3
  s_waitcnt lgkmcnt(2)
  v_mfma_f32_32x32x16_bf16 v[96:111], v[28:31], v[12:15], v[64:79]
  v_exp_f32 v80, v80
  v_exp_f32 v81, v81
  v_exp_f32 v82, v82
  v_mfma_f32_16x16x32_bf16 v[24:27], v[20:23], v[56:59], v[24:27]
  v_exp_f32 v83, v83
  v_cvt_pk_bf16_f32 v44, v80, v81
  v_exp_f32 v84, v84
  v_mfma_f32_32x32x16_bf16 v[96:111], v[32:35], v[16:19], v[96:111]
  v_exp_f32 v85, v85
  v_cvt_pk_bf16_f32 v45, v82, v83
  v_exp_f32 v86, v86
  v_exp_f32 v87, v87
  v_cmp_nge_f32 vcc, s48, v24
  ds_read_b128 v[28:31], v8 offset:0
  v_cvt_pk_bf16_f32 v46, v84, v85
  ds_read_b128 v[32:35], v8 offset:1024
  s_waitcnt lgkmcnt(2)
  s_cbranch_vccnz L_slow_39
L_ret_40:
  v_mfma_f32_32x32x16_bf16 v[112:127], v[36:39], v[52:55], v[112:127]
  v_add_f32 v10, v10, v24
  v_exp_f32 v88, v88
  v_exp_f32 v89, v89
  v_cvt_pk_bf16_f32 v47, v86, v87
  v_exp_f32 v90, v90
  v_mfma_f32_32x32x16_bf16 v[112:127], v[40:43], v[56:59], v[112:127]
  v_exp_f32 v91, v91
  v_cvt_pk_bf16_f32 v48, v88, v89
  v_exp_f32 v92, v92
  v_exp_f32 v93, v93
  v_mfma_f32_16x16x32_bf16 v[24:27], v[20:23], v[44:47], 0
  ds_read_b128 v[36:39], v7 offset:10240
  v_cvt_pk_bf16_f32 v49, v90, v91
  ds_read_b128 v[40:43], v7 offset:11264
  v_exp_f32 v94, v94
  v_exp_f32 v95, v95
  v_cvt_pk_bf16_f32 v50, v92, v93
  v_cvt_pk_bf16_f32 v51, v94, v95
  s_setprio 2
  s_waitcnt lgkmcnt(2)
  v_mfma_f32_32x32x16_bf16 v[80:95], v[28:31], v[12:15], v[64:79]
  v_exp_f32 v96, v96
  v_exp_f32 v97, v97
  v_exp_f32 v98, v98
  v_mfma_f32_16x16x32_bf16 v[24:27], v[20:23], v[48:51], v[24:27]
  v_exp_f32 v99, v99
  v_cvt_pk_bf16_f32 v52, v96, v97
  v_exp_f32 v100, v100
  v_mfma_f32_32x32x16_bf16 v[80:95], v[32:35], v[16:19], v[80:95]
  v_exp_f32 v101, v101
  v_cvt_pk_bf16_f32 v53, v98, v99
  v_exp_f32 v102, v102
  v_exp_f32 v103, v103
  v_cmp_nge_f32 vcc, s48, v24
  ds_read_b128 v[28:31], v8 offset:4096
  v_cvt_pk_bf16_f32 v54, v100, v101
  ds_read_b128 v[32:35], v8 offset:5120
  s_waitcnt lgkmcnt(2)
  s_cbranch_vccnz L_slow_41
L_ret_42:
  v_mfma_f32_32x32x16_bf16 v[112:127], v[36:39], v[44:47], v[112:127]
  v_add_f32 v10, v10, v24
  v_exp_f32 v104, v104
  v_exp_f32 v105, v105
  v_cvt_pk_bf16_f32 v55, v102, v103
  v_exp_f32 v106, v106
  v_mfma_f32_32x32x16_bf16 v[112:127], v[40:43], v[48:51], v[112:127]
  v_exp_f32 v107, v107
  v_cvt_pk_bf16_f32 v56, v104, v105
  v_exp_f32 v108, v108
  v_exp_f32 v109, v109
  v_mfma_f32_16x16x32_bf16 v[24:27], v[20:23], v[52:55], 0
  ds_read_b128 v[36:39], v7 offset:14336
  v_cvt_pk_bf16_f32 v57, v106, v107
  ds_read_b128 v[40:43], v7 offset:15360
  v_exp_f32 v110, v110
  v_exp_f32 v111, v111
  v_cvt_pk_bf16_f32 v58, v108, v109
  v_cvt_pk_bf16_f32 v59, v110, v111
  v_mov_b32 v1, v6
  v_mov_b32 v6, v7
  v_mov_b32 v7, v8
  v_mov_b32 v8, v1
  s_add_u32 s47, s47, 1
  s_cmp_lt_u32 s47, 16
  s_cbranch_scc1 L_loop_34
  s_setprio 1
  s_waitcnt lgkmcnt(0)
  s_nop 1
  v_mfma_f32_16x16x32_bf16 v[24:27], v[20:23], v[56:59], v[24:27]
  s_nop 7
  v_cmp_nge_f32 vcc, s48, v24
  s_cbranch_vccnz L_slow_43
L_ret_44:
  v_mfma_f32_32x32x16_bf16 v[112:127], v[36:39], v[52:55], v[112:127]
  v_add_f32 v10, v10, v24
  v_mfma_f32_32x32x16_bf16 v[112:127], v[40:43], v[56:59], v[112:127]
  v_rcp_f32 v1, v10
  s_nop 11
  v_mul_f32 v112, v112, v1
  v_mul_f32 v113, v113, v1
  v_mul_f32 v114, v114, v1
  v_mul_f32 v115, v115, v1
  v_mul_f32 v116, v116, v1
  v_mul_f32 v117, v117, v1
  v_mul_f32 v118, v118, v1
  v_mul_f32 v119, v119, v1
  v_mul_f32 v120, v120, v1
  v_mul_f32 v121, v121, v1
  v_mul_f32 v122, v122, v1
  v_mul_f32 v123, v123, v1
  v_mul_f32 v124, v124, v1
  v_mul_f32 v125, v125, v1
  v_mul_f32 v126, v126, v1
  v_mul_f32 v127, v127, v1
  v_cvt_pk_bf16_f32 v128, v112, v113
  v_cvt_pk_bf16_f32 v129, v114, v115
  v_cvt_pk_bf16_f32 v130, v116, v117
  v_cvt_pk_bf16_f32 v131, v118, v119
  v_cvt_pk_bf16_f32 v132, v120, v121
  v_cvt_pk_bf16_f32 v133, v122, v123
  v_cvt_pk_bf16_f32 v134, v124, v125
  v_cvt_pk_bf16_f32 v135, v126, v127
  s_add_u32 s64, s43, 5242880
  buffer_store_dwordx4 v[128:131], v5, s[32:35], s64 offen
  buffer_store_dwordx4 v[132:135], v5, s[32:35], s64 offen offset:1024
L_end_1:
  s_endpgm
L_fb_33:
  s_barrier
  s_mov_b32 s74, 0
L_fbl_45:
  s_and_b32 s72, s74, 7
  s_lshr_b32 s73, s74, 3
  s_mov_b32 s16, s96
  s_mov_b32 s17, s97
  s_mov_b32 s18, 4194304
  s_mov_b32 s19, 0x20000
  s_bitcmp1_b32 s73, 0
  s_cselect_b32 s20, s58, s56
  s_cselect_b32 s21, s59, s57
  s_mov_b32 s22, 65536
  s_mov_b32 s23, 0x20000
  s_lshl_b32 s45, s42, 13
  s_cmp_ge_u32 s42, 6
  s_cselect_b32 s40, 98304, 0
  s_add_u32 s40, s40, s45
  s_add_u32 m0, s40, 0
  s_add_u32 s64, s45, 0
  buffer_load_dwordx4 v5, s[20:23], s64 offen lds
  s_add_u32 m0, s40, 1024
  s_add_u32 s64, s45, 1024
  buffer_load_dwordx4 v5, s[20:23], s64 offen lds
  s_add_u32 m0, s40, 2048
  s_add_u32 s64, s45, 2048
  buffer_load_dwordx4 v5, s[20:23], s64 offen lds
  s_add_u32 m0, s40, 3072
  s_add_u32 s64, s45, 3072
  buffer_load_dwordx4 v5, s[20:23], s64 offen lds
  s_add_u32 m0, s40, 4096
  s_add_u32 s64, s45, 4096
  buffer_load_dwordx4 v5, s[20:23], s64 offen lds
  s_add_u32 m0, s40, 5120
  s_add_u32 s64, s45, 5120
  buffer_load_dwordx4 v5, s[20:23], s64 offen lds
  s_add_u32 m0, s40, 6144
  s_add_u32 s64, s45, 6144
  buffer_load_dwordx4 v5, s[20:23], s64 offen lds
  s_add_u32 m0, s40, 7168
  s_add_u32 s64, s45, 7168
  buffer_load_dwordx4 v5, s[20:23], s64 offen lds
  s_lshl_b32 s46, s72, 4
  s_lshr_b32 s64, s73, 1
  s_add_u32 s46, s46, s64
  s_lshl_b32 s45, s46, 15
  s_lshl_b32 s64, s42, 8
  s_add_u32 s45, s45, s64
  v_and_b32 v1, 15, v4
  v_lshrrev_b32 v2, 4, v4
  v_lshlrev_b32 v3, 4, v2
  v_lshl_add_u32 v3, v1, 11, v3
  buffer_load_dwordx4 v[64:67], v3, s[16:19], s45 offen offset:0
  buffer_load_dwordx4 v[68:71], v3, s[16:19], s45 offen offset:64
  buffer_load_dwordx4 v[72:75], v3, s[16:19], s45 offen offset:128
  buffer_load_dwordx4 v[76:79], v3, s[16:19], s45 offen offset:192
  v_and_b32 v3, 1, v2
  v_lshl_add_u32 v3, v3, 5, v1
  v_lshlrev_b32 v3, 4, v3
  v_lshrrev_b32 v8, 1, v2
  v_lshl_add_u32 v8, v8, 3, v3
  v_bfe_u32 v1, v4, 2, 2
  v_lshl_add_u32 v1, v2, 3, v1
  v_lshlrev_b32 v1, 6, v1
  v_and_b32 v2, 3, v4
  v_lshl_add_u32 v1, v2, 3, v1
  v_add_u32 v9, s40, v1
  s_lshr_b32 s41, s46, 1
  s_lshl_b32 s41, s41, 12
  s_add_u32 s41, s41, 4194304
  s_and_b32 s46, s46, 1
  s_bitcmp1_b32 s73, 0
  s_cselect_b32 s45, 10, 8
  s_cselect_b32 s49, 1, 4
  s_cselect_b32 s64, 2048, 0
  s_add_u32 s41, s41, s64
  s_lshl_b32 s46, s46, s45
  s_add_u32 s41, s41, s46
  s_lshl_b32 s49, s49, 8
  s_add_u32 s49, s49, s41
  s_waitcnt vmcnt(0)
  ds_read_b64_tr_b16 v[80:81], v9 offset:0
  ds_read_b64_tr_b16 v[82:83], v9 offset:256
  ds_read_b64_tr_b16 v[84:85], v9 offset:32
  ds_read_b64_tr_b16 v[86:87], v9 offset:288
  ds_read_b64_tr_b16 v[88:89], v9 offset:2048
  ds_read_b64_tr_b16 v[90:91], v9 offset:2304
  ds_read_b64_tr_b16 v[92:93], v9 offset:2080
  ds_read_b64_tr_b16 v[94:95], v9 offset:2336
  s_waitcnt lgkmcnt(4)
  ds_read_b64_tr_b16 v[96:97], v9 offset:4096
  ds_read_b64_tr_b16 v[98:99], v9 offset:4352
  ds_read_b64_tr_b16 v[100:101], v9 offset:4128
  ds_read_b64_tr_b16 v[102:103], v9 offset:4384
  ds_read_b64_tr_b16 v[104:105], v9 offset:6144
  ds_read_b64_tr_b16 v[106:107], v9 offset:6400
  ds_read_b64_tr_b16 v[108:109], v9 offset:6176
  ds_read_b64_tr_b16 v[110:111], v9 offset:6432
  s_waitcnt lgkmcnt(0)
  s_bitcmp1_b32 s73, 0
  s_cbranch_scc1 L_kvv_46
  v_mfma_f32_16x16x32_bf16 v[112:115], v[80:83], v[64:67], 0
  v_mfma_f32_16x16x32_bf16 v[116:119], v[84:87], v[64:67], 0
  v_mfma_f32_16x16x32_bf16 v[112:115], v[88:91], v[68:71], v[112:115]
  v_mfma_f32_16x16x32_bf16 v[116:119], v[92:95], v[68:71], v[116:119]
  v_mfma_f32_16x16x32_bf16 v[112:115], v[96:99], v[72:75], v[112:115]
  v_mfma_f32_16x16x32_bf16 v[116:119], v[100:103], v[72:75], v[116:119]
  v_mfma_f32_16x16x32_bf16 v[112:115], v[104:107], v[76:79], v[112:115]
  v_mfma_f32_16x16x32_bf16 v[116:119], v[108:111], v[76:79], v[116:119]
  s_branch L_kvj_47
L_kvv_46:
  v_mfma_f32_16x16x32_bf16 v[112:115], v[64:67], v[80:83], 0
  v_mfma_f32_16x16x32_bf16 v[116:119], v[64:67], v[84:87], 0
  v_mfma_f32_16x16x32_bf16 v[112:115], v[68:71], v[88:91], v[112:115]
  v_mfma_f32_16x16x32_bf16 v[116:119], v[68:71], v[92:95], v[116:119]
  v_mfma_f32_16x16x32_bf16 v[112:115], v[72:75], v[96:99], v[112:115]
  v_mfma_f32_16x16x32_bf16 v[116:119], v[72:75], v[100:103], v[116:119]
  v_mfma_f32_16x16x32_bf16 v[112:115], v[76:79], v[104:107], v[112:115]
  v_mfma_f32_16x16x32_bf16 v[116:119], v[76:79], v[108:111], v[116:119]
L_kvj_47:
  v_add_u32 v9, s40, v5
  s_nop 15
  ds_write_b128 v9, v[112:115] offset:0
  ds_write_b128 v9, v[116:119] offset:1024
  s_waitcnt lgkmcnt(0)
  s_barrier
  s_cmp_lt_u32 s42, 7
  s_cbranch_scc1 L_kvn_48
  v_add_u32 v10, 147456, v5
  ds_read_b128 v[64:67], v5 offset:0
  ds_read_b128 v[68:71], v5 offset:8192
  ds_read_b128 v[72:75], v5 offset:16384
  ds_read_b128 v[76:79], v5 offset:24576
  ds_read_b128 v[80:83], v5 offset:32768
  ds_read_b128 v[84:87], v5 offset:40960
  ds_read_b128 v[88:91], v10 offset:0
  ds_read_b128 v[92:95], v10 offset:8192
  s_waitcnt lgkmcnt(6)
  v_add_f32 v64, v64, v68
  v_add_f32 v65, v65, v69
  v_add_f32 v66, v66, v70
  v_add_f32 v67, v67, v71
  s_waitcnt lgkmcnt(5)
  v_add_f32 v64, v64, v72
  v_add_f32 v65, v65, v73
  v_add_f32 v66, v66, v74
  v_add_f32 v67, v67, v75
  s_waitcnt lgkmcnt(4)
  v_add_f32 v64, v64, v76
  v_add_f32 v65, v65, v77
  v_add_f32 v66, v66, v78
  v_add_f32 v67, v67, v79
  s_waitcnt lgkmcnt(3)
  v_add_f32 v64, v64, v80
  v_add_f32 v65, v65, v81
  v_add_f32 v66, v66, v82
  v_add_f32 v67, v67, v83
  s_waitcnt lgkmcnt(2)
  v_add_f32 v64, v64, v84
  v_add_f32 v65, v65, v85
  v_add_f32 v66, v66, v86
  v_add_f32 v67, v67, v87
  s_waitcnt lgkmcnt(1)
  v_add_f32 v64, v64, v88
  v_add_f32 v65, v65, v89
  v_add_f32 v66, v66, v90
  v_add_f32 v67, v67, v91
  s_waitcnt lgkmcnt(0)
  v_add_f32 v64, v64, v92
  v_add_f32 v65, v65, v93
  v_add_f32 v66, v66, v94
  v_add_f32 v67, v67, v95
  v_cvt_pk_bf16_f32 v58, v64, v65
  v_cvt_pk_bf16_f32 v59, v66, v67
  buffer_store_dwordx2 v[58:59], v8, s[32:35], s41 offen sc0 sc1
  ds_read_b128 v[96:99], v5 offset:1024
  ds_read_b128 v[100:103], v5 offset:9216
  ds_read_b128 v[104:107], v5 offset:17408
  ds_read_b128 v[108:111], v5 offset:25600
  ds_read_b128 v[112:115], v5 offset:33792
  ds_read_b128 v[116:119], v5 offset:41984
  ds_read_b128 v[120:123], v10 offset:1024
  ds_read_b128 v[124:127], v10 offset:9216
  s_waitcnt lgkmcnt(6)
  v_add_f32 v96, v96, v100
  v_add_f32 v97, v97, v101
  v_add_f32 v98, v98, v102
  v_add_f32 v99, v99, v103
  s_waitcnt lgkmcnt(5)
  v_add_f32 v96, v96, v104
  v_add_f32 v97, v97, v105
  v_add_f32 v98, v98, v106
  v_add_f32 v99, v99, v107
  s_waitcnt lgkmcnt(4)
  v_add_f32 v96, v96, v108
  v_add_f32 v97, v97, v109
  v_add_f32 v98, v98, v110
  v_add_f32 v99, v99, v111
  s_waitcnt lgkmcnt(3)
  v_add_f32 v96, v96, v112
  v_add_f32 v97, v97, v113
  v_add_f32 v98, v98, v114
  v_add_f32 v99, v99, v115
  s_waitcnt lgkmcnt(2)
  v_add_f32 v96, v96, v116
  v_add_f32 v97, v97, v117
  v_add_f32 v98, v98, v118
  v_add_f32 v99, v99, v119
  s_waitcnt lgkmcnt(1)
  v_add_f32 v96, v96, v120
  v_add_f32 v97, v97, v121
  v_add_f32 v98, v98, v122
  v_add_f32 v99, v99, v123
  s_waitcnt lgkmcnt(0)
  v_add_f32 v96, v96, v124
  v_add_f32 v97, v97, v125
  v_add_f32 v98, v98, v126
  v_add_f32 v99, v99, v127
  v_cvt_pk_bf16_f32 v60, v96, v97
  v_cvt_pk_bf16_f32 v61, v98, v99
  buffer_store_dwordx2 v[60:61], v8, s[32:35], s49 offen sc0 sc1
L_kvn_48:
  s_waitcnt lgkmcnt(0)
  s_barrier
  s_add_u32 s74, s74, 1
  s_cmp_lt_u32 s74, 256
  s_cbranch_scc1 L_fbl_45
  s_waitcnt vmcnt(0)
  s_barrier
  s_branch L_init_32
L_slow_35:
  ds_read_b128 v[128:131], v6 offset:12288
  ds_read_b128 v[132:135], v6 offset:13312
  s_waitcnt lgkmcnt(0)
  v_mfma_f32_32x32x16_bf16 v[144:159], v[128:131], v[12:15], 0
  v_mfma_f32_32x32x16_bf16 v[144:159], v[132:135], v[16:19], v[144:159]
  s_nop 15
  v_max3_f32 v1, v144, v145, v146
  v_max3_f32 v1, v1, v147, v148
  v_max3_f32 v1, v1, v149, v150
  v_max3_f32 v1, v1, v151, v152
  v_max3_f32 v1, v1, v153, v154
  v_max3_f32 v1, v1, v155, v156
  v_max3_f32 v1, v1, v157, v158
  v_max_f32 v1, v1, v159
  v_mov_b32 v2, v1
  s_nop 1
  v_permlane32_swap_b32 v1, v2
  s_nop 1
  v_max_f32 v1, v1, v2
  v_add_f32 v1, 0x42b40000, v1
  v_max_f32 v1, v1, v9
  v_sub_f32 v2, v9, v1
  v_mul_f32 v2, 0.5, v2
  v_exp_f32 v2, v2
  v_mov_b32 v9, v1
  v_sub_f32 v3, 0, v1
  v_mul_f32 v112, v112, v2
  v_mov_b32 v64, v3
  v_mul_f32 v112, v112, v2
  v_sub_f32 v144, v144, v1
  v_mul_f32 v113, v113, v2
  v_mov_b32 v65, v3
  v_mul_f32 v113, v113, v2
  v_sub_f32 v145, v145, v1
  v_mul_f32 v114, v114, v2
  v_mov_b32 v66, v3
  v_mul_f32 v114, v114, v2
  v_sub_f32 v146, v146, v1
  v_mul_f32 v115, v115, v2
  v_mov_b32 v67, v3
  v_mul_f32 v115, v115, v2
  v_sub_f32 v147, v147, v1
  v_mul_f32 v116, v116, v2
  v_mov_b32 v68, v3
  v_mul_f32 v116, v116, v2
  v_sub_f32 v148, v148, v1
  v_mul_f32 v117, v117, v2
  v_mov_b32 v69, v3
  v_mul_f32 v117, v117, v2
  v_sub_f32 v149, v149, v1
  v_mul_f32 v118, v118, v2
  v_mov_b32 v70, v3
  v_mul_f32 v118, v118, v2
  v_sub_f32 v150, v150, v1
  v_mul_f32 v119, v119, v2
  v_mov_b32 v71, v3
  v_mul_f32 v119, v119, v2
  v_sub_f32 v151, v151, v1
  v_mul_f32 v120, v120, v2
  v_mov_b32 v72, v3
  v_mul_f32 v120, v120, v2
  v_sub_f32 v152, v152, v1
  v_mul_f32 v121, v121, v2
  v_mov_b32 v73, v3
  v_mul_f32 v121, v121, v2
  v_sub_f32 v153, v153, v1
  v_mul_f32 v122, v122, v2
  v_mov_b32 v74, v3
  v_mul_f32 v122, v122, v2
  v_sub_f32 v154, v154, v1
  v_mul_f32 v123, v123, v2
  v_mov_b32 v75, v3
  v_mul_f32 v123, v123, v2
  v_sub_f32 v155, v155, v1
  v_mul_f32 v124, v124, v2
  v_mov_b32 v76, v3
  v_mul_f32 v124, v124, v2
  v_sub_f32 v156, v156, v1
  v_mul_f32 v125, v125, v2
  v_mov_b32 v77, v3
  v_mul_f32 v125, v125, v2
  v_sub_f32 v157, v157, v1
  v_mul_f32 v126, v126, v2
  v_mov_b32 v78, v3
  v_mul_f32 v126, v126, v2
  v_sub_f32 v158, v158, v1
  v_mul_f32 v127, v127, v2
  v_mov_b32 v79, v3
  v_mul_f32 v127, v127, v2
  v_sub_f32 v159, v159, v1
  v_mul_f32 v10, v10, v2
  v_mul_f32 v10, v10, v2
  v_exp_f32 v144, v144
  v_exp_f32 v145, v145
  v_exp_f32 v146, v146
  v_exp_f32 v147, v147
  v_exp_f32 v148, v148
  v_exp_f32 v149, v149
  v_exp_f32 v150, v150
  v_exp_f32 v151, v151
  v_exp_f32 v152, v152
  v_exp_f32 v153, v153
  v_exp_f32 v154, v154
  v_exp_f32 v155, v155
  v_exp_f32 v156, v156
  v_exp_f32 v157, v157
  v_exp_f32 v158, v158
  v_exp_f32 v159, v159
  s_nop 0
  v_cvt_pk_bf16_f32 v52, v144, v145
  v_cvt_pk_bf16_f32 v53, v146, v147
  v_cvt_pk_bf16_f32 v54, v148, v149
  v_cvt_pk_bf16_f32 v55, v150, v151
  v_cvt_pk_bf16_f32 v56, v152, v153
  v_cvt_pk_bf16_f32 v57, v154, v155
  v_cvt_pk_bf16_f32 v58, v156, v157
  v_cvt_pk_bf16_f32 v59, v158, v159
  s_nop 1
  v_mfma_f32_16x16x32_bf16 v[24:27], v[20:23], v[52:55], 0
  v_mfma_f32_16x16x32_bf16 v[24:27], v[20:23], v[56:59], v[24:27]
  ds_read_b128 v[128:131], v7 offset:0
  ds_read_b128 v[132:135], v7 offset:1024
  s_waitcnt lgkmcnt(0)
  v_mfma_f32_32x32x16_bf16 v[80:95], v[128:131], v[12:15], v[64:79]
  v_mfma_f32_32x32x16_bf16 v[80:95], v[132:135], v[16:19], v[80:95]
  s_nop 7
  ds_read_b128 v[128:131], v7 offset:4096
  ds_read_b128 v[132:135], v7 offset:5120
  s_waitcnt lgkmcnt(0)
  v_mfma_f32_32x32x16_bf16 v[96:111], v[128:131], v[12:15], v[64:79]
  v_mfma_f32_32x32x16_bf16 v[96:111], v[132:135], v[16:19], v[96:111]
  s_nop 15
  s_nop 0
  v_exp_f32 v80, v80
  s_nop 0
  v_exp_f32 v81, v81
  s_nop 0
  v_exp_f32 v82, v82
  s_nop 0
  v_exp_f32 v83, v83
  s_nop 0
  v_cvt_pk_bf16_f32 v44, v80, v81
  s_nop 0
  v_exp_f32 v84, v84
  s_nop 0
  v_exp_f32 v85, v85
  s_nop 0
  v_cvt_pk_bf16_f32 v45, v82, v83
  s_nop 0
  v_exp_f32 v86, v86
  s_nop 0
  v_exp_f32 v87, v87
  s_nop 0
  v_cvt_pk_bf16_f32 v46, v84, v85
  s_nop 1
  s_branch L_ret_36
L_slow_37:
  ds_read_b128 v[128:131], v7 offset:0
  ds_read_b128 v[132:135], v7 offset:1024
  s_waitcnt lgkmcnt(0)
  v_mfma_f32_32x32x16_bf16 v[144:159], v[128:131], v[12:15], 0
  v_mfma_f32_32x32x16_bf16 v[144:159], v[132:135], v[16:19], v[144:159]
  s_nop 15
  v_max3_f32 v1, v144, v145, v146
  v_max3_f32 v1, v1, v147, v148
  v_max3_f32 v1, v1, v149, v150
  v_max3_f32 v1, v1, v151, v152
  v_max3_f32 v1, v1, v153, v154
  v_max3_f32 v1, v1, v155, v156
  v_max3_f32 v1, v1, v157, v158
  v_max_f32 v1, v1, v159
  v_mov_b32 v2, v1
  s_nop 1
  v_permlane32_swap_b32 v1, v2
  s_nop 1
  v_max_f32 v1, v1, v2
  v_add_f32 v1, 0x42b40000, v1
  v_max_f32 v1, v1, v9
  v_sub_f32 v2, v9, v1
  v_mul_f32 v2, 0.5, v2
  v_exp_f32 v2, v2
  v_mov_b32 v9, v1
  v_sub_f32 v3, 0, v1
  v_mul_f32 v112, v112, v2
  v_mov_b32 v64, v3
  v_mul_f32 v112, v112, v2
  v_sub_f32 v144, v144, v1
  v_mul_f32 v113, v113, v2
  v_mov_b32 v65, v3
  v_mul_f32 v113, v113, v2
  v_sub_f32 v145, v145, v1
  v_mul_f32 v114, v114, v2
  v_mov_b32 v66, v3
  v_mul_f32 v114, v114, v2
  v_sub_f32 v146, v146, v1
  v_mul_f32 v115, v115, v2
  v_mov_b32 v67, v3
  v_mul_f32 v115, v115, v2
  v_sub_f32 v147, v147, v1
  v_mul_f32 v116, v116, v2
  v_mov_b32 v68, v3
  v_mul_f32 v116, v116, v2
  v_sub_f32 v148, v148, v1
  v_mul_f32 v117, v117, v2
  v_mov_b32 v69, v3
  v_mul_f32 v117, v117, v2
  v_sub_f32 v149, v149, v1
  v_mul_f32 v118, v118, v2
  v_mov_b32 v70, v3
  v_mul_f32 v118, v118, v2
  v_sub_f32 v150, v150, v1
  v_mul_f32 v119, v119, v2
  v_mov_b32 v71, v3
  v_mul_f32 v119, v119, v2
  v_sub_f32 v151, v151, v1
  v_mul_f32 v120, v120, v2
  v_mov_b32 v72, v3
  v_mul_f32 v120, v120, v2
  v_sub_f32 v152, v152, v1
  v_mul_f32 v121, v121, v2
  v_mov_b32 v73, v3
  v_mul_f32 v121, v121, v2
  v_sub_f32 v153, v153, v1
  v_mul_f32 v122, v122, v2
  v_mov_b32 v74, v3
  v_mul_f32 v122, v122, v2
  v_sub_f32 v154, v154, v1
  v_mul_f32 v123, v123, v2
  v_mov_b32 v75, v3
  v_mul_f32 v123, v123, v2
  v_sub_f32 v155, v155, v1
  v_mul_f32 v124, v124, v2
  v_mov_b32 v76, v3
  v_mul_f32 v124, v124, v2
  v_sub_f32 v156, v156, v1
  v_mul_f32 v125, v125, v2
  v_mov_b32 v77, v3
  v_mul_f32 v125, v125, v2
  v_sub_f32 v157, v157, v1
  v_mul_f32 v126, v126, v2
  v_mov_b32 v78, v3
  v_mul_f32 v126, v126, v2
  v_sub_f32 v158, v158, v1
  v_mul_f32 v127, v127, v2
  v_mov_b32 v79, v3
  v_mul_f32 v127, v127, v2
  v_sub_f32 v159, v159, v1
  v_mul_f32 v10, v10, v2
  v_mul_f32 v10, v10, v2
  v_exp_f32 v144, v144
  v_exp_f32 v145, v145
  v_exp_f32 v146, v146
  v_exp_f32 v147, v147
  v_exp_f32 v148, v148
  v_exp_f32 v149, v149
  v_exp_f32 v150, v150
  v_exp_f32 v151, v151
  v_exp_f32 v152, v152
  v_exp_f32 v153, v153
  v_exp_f32 v154, v154
  v_exp_f32 v155, v155
  v_exp_f32 v156, v156
  v_exp_f32 v157, v157
  v_exp_f32 v158, v158
  v_exp_f32 v159, v159
  s_nop 0
  v_cvt_pk_bf16_f32 v44, v144, v145
  v_cvt_pk_bf16_f32 v45, v146, v147
  v_cvt_pk_bf16_f32 v46, v148, v149
  v_cvt_pk_bf16_f32 v47, v150, v151
  v_cvt_pk_bf16_f32 v48, v152, v153
  v_cvt_pk_bf16_f32 v49, v154, v155
  v_cvt_pk_bf16_f32 v50, v156, v157
  v_cvt_pk_bf16_f32 v51, v158, v159
  s_nop 1
  v_mfma_f32_16x16x32_bf16 v[24:27], v[20:23], v[44:47], 0
  v_mfma_f32_16x16x32_bf16 v[24:27], v[20:23], v[48:51], v[24:27]
  ds_read_b128 v[128:131], v7 offset:4096
  ds_read_b128 v[132:135], v7 offset:5120
  s_waitcnt lgkmcnt(0)
  v_mfma_f32_32x32x16_bf16 v[96:111], v[128:131], v[12:15], v[64:79]
  v_mfma_f32_32x32x16_bf16 v[96:111], v[132:135], v[16:19], v[96:111]
  s_nop 7
  ds_read_b128 v[128:131], v7 offset:8192
  ds_read_b128 v[132:135], v7 offset:9216
  s_waitcnt lgkmcnt(0)
  v_mfma_f32_32x32x16_bf16 v[80:95], v[128:131], v[12:15], v[64:79]
  v_mfma_f32_32x32x16_bf16 v[80:95], v[132:135], v[16:19], v[80:95]
  s_nop 15
  s_nop 0
  v_exp_f32 v96, v96
  s_nop 0
  v_exp_f32 v97, v97
  s_nop 0
  v_exp_f32 v98, v98
  s_nop 0
  v_exp_f32 v99, v99
  s_nop 0
  v_cvt_pk_bf16_f32 v52, v96, v97
  s_nop 0
  v_exp_f32 v100, v100
  s_nop 0
  v_exp_f32 v101, v101
  s_nop 0
  v_cvt_pk_bf16_f32 v53, v98, v99
  s_nop 0
  v_exp_f32 v102, v102
  s_nop 0
  v_exp_f32 v103, v103
  s_nop 0
  v_cvt_pk_bf16_f32 v54, v100, v101
  s_nop 1
  s_branch L_ret_38
L_slow_39:
  ds_read_b128 v[128:131], v7 offset:4096
  ds_read_b128 v[132:135], v7 offset:5120
  s_waitcnt lgkmcnt(0)
  v_mfma_f32_32x32x16_bf16 v[144:159], v[128:131], v[12:15], 0
  v_mfma_f32_32x32x16_bf16 v[144:159], v[132:135], v[16:19], v[144:159]
  s_nop 15
  v_max3_f32 v1, v144, v145, v146
  v_max3_f32 v1, v1, v147, v148
  v_max3_f32 v1, v1, v149, v150
  v_max3_f32 v1, v1, v151, v152
  v_max3_f32 v1, v1, v153, v154
  v_max3_f32 v1, v1, v155, v156
  v_max3_f32 v1, v1, v157, v158
  v_max_f32 v1, v1, v159
  v_mov_b32 v2, v1
  s_nop 1
  v_permlane32_swap_b32 v1, v2
  s_nop 1
  v_max_f32 v1, v1, v2
  v_add_f32 v1, 0x42b40000, v1
  v_max_f32 v1, v1, v9
  v_sub_f32 v2, v9, v1
  v_mul_f32 v2, 0.5, v2
  v_exp_f32 v2, v2
  v_mov_b32 v9, v1
  v_sub_f32 v3, 0, v1
  v_mul_f32 v112, v112, v2
  v_mov_b32 v64, v3
  v_mul_f32 v112, v112, v2
  v_sub_f32 v144, v144, v1
  v_mul_f32 v113, v113, v2
  v_mov_b32 v65, v3
  v_mul_f32 v113, v113, v2
  v_sub_f32 v145, v145, v1
  v_mul_f32 v114, v114, v2
  v_mov_b32 v66, v3
  v_mul_f32 v114, v114, v2
  v_sub_f32 v146, v146, v1
  v_mul_f32 v115, v115, v2
  v_mov_b32 v67, v3
  v_mul_f32 v115, v115, v2
  v_sub_f32 v147, v147, v1
  v_mul_f32 v116, v116, v2
  v_mov_b32 v68, v3
  v_mul_f32 v116, v116, v2
  v_sub_f32 v148, v148, v1
  v_mul_f32 v117, v117, v2
  v_mov_b32 v69, v3
  v_mul_f32 v117, v117, v2
  v_sub_f32 v149, v149, v1
  v_mul_f32 v118, v118, v2
  v_mov_b32 v70, v3
  v_mul_f32 v118, v118, v2
  v_sub_f32 v150, v150, v1
  v_mul_f32 v119, v119, v2
  v_mov_b32 v71, v3
  v_mul_f32 v119, v119, v2
  v_sub_f32 v151, v151, v1
  v_mul_f32 v120, v120, v2
  v_mov_b32 v72, v3
  v_mul_f32 v120, v120, v2
  v_sub_f32 v152, v152, v1
  v_mul_f32 v121, v121, v2
  v_mov_b32 v73, v3
  v_mul_f32 v121, v121, v2
  v_sub_f32 v153, v153, v1
  v_mul_f32 v122, v122, v2
  v_mov_b32 v74, v3
  v_mul_f32 v122, v122, v2
  v_sub_f32 v154, v154, v1
  v_mul_f32 v123, v123, v2
  v_mov_b32 v75, v3
  v_mul_f32 v123, v123, v2
  v_sub_f32 v155, v155, v1
  v_mul_f32 v124, v124, v2
  v_mov_b32 v76, v3
  v_mul_f32 v124, v124, v2
  v_sub_f32 v156, v156, v1
  v_mul_f32 v125, v125, v2
  v_mov_b32 v77, v3
  v_mul_f32 v125, v125, v2
  v_sub_f32 v157, v157, v1
  v_mul_f32 v126, v126, v2
  v_mov_b32 v78, v3
  v_mul_f32 v126, v126, v2
  v_sub_f32 v158, v158, v1
  v_mul_f32 v127, v127, v2
  v_mov_b32 v79, v3
  v_mul_f32 v127, v127, v2
  v_sub_f32 v159, v159, v1
  v_mul_f32 v10, v10, v2
  v_mul_f32 v10, v10, v2
  v_exp_f32 v144, v144
  v_exp_f32 v145, v145
  v_exp_f32 v146, v146
  v_exp_f32 v147, v147
  v_exp_f32 v148, v148
  v_exp_f32 v149, v149
  v_exp_f32 v150, v150
  v_exp_f32 v151, v151
  v_exp_f32 v152, v152
  v_exp_f32 v153, v153
  v_exp_f32 v154, v154
  v_exp_f32 v155, v155
  v_exp_f32 v156, v156
  v_exp_f32 v157, v157
  v_exp_f32 v158, v158
  v_exp_f32 v159, v159
  s_nop 0
  v_cvt_pk_bf16_f32 v52, v144, v145
  v_cvt_pk_bf16_f32 v53, v146, v147
  v_cvt_pk_bf16_f32 v54, v148, v149
  v_cvt_pk_bf16_f32 v55, v150, v151
  v_cvt_pk_bf16_f32 v56, v152, v153
  v_cvt_pk_bf16_f32 v57, v154, v155
  v_cvt_pk_bf16_f32 v58, v156, v157
  v_cvt_pk_bf16_f32 v59, v158, v159
  s_nop 1
  v_mfma_f32_16x16x32_bf16 v[24:27], v[20:23], v[52:55], 0
  v_mfma_f32_16x16x32_bf16 v[24:27], v[20:23], v[56:59], v[24:27]
  ds_read_b128 v[128:131], v7 offset:8192
  ds_read_b128 v[132:135], v7 offset:9216
  s_waitcnt lgkmcnt(0)
  v_mfma_f32_32x32x16_bf16 v[80:95], v[128:131], v[12:15], v[64:79]
  v_mfma_f32_32x32x16_bf16 v[80:95], v[132:135], v[16:19], v[80:95]
  s_nop 7
  ds_read_b128 v[128:131], v7 offset:12288
  ds_read_b128 v[132:135], v7 offset:13312
  s_waitcnt lgkmcnt(0)
  v_mfma_f32_32x32x16_bf16 v[96:111], v[128:131], v[12:15], v[64:79]
  v_mfma_f32_32x32x16_bf16 v[96:111], v[132:135], v[16:19], v[96:111]
  s_nop 15
  s_nop 0
  v_exp_f32 v80, v80
  s_nop 0
  v_exp_f32 v81, v81
  s_nop 0
  v_exp_f32 v82, v82
  s_nop 0
  v_exp_f32 v83, v83
  s_nop 0
  v_cvt_pk_bf16_f32 v44, v80, v81
  s_nop 0
  v_exp_f32 v84, v84
  s_nop 0
  v_exp_f32 v85, v85
  s_nop 0
  v_cvt_pk_bf16_f32 v45, v82, v83
  s_nop 0
  v_exp_f32 v86, v86
  s_nop 0
  v_exp_f32 v87, v87
  s_nop 0
  v_cvt_pk_bf16_f32 v46, v84, v85
  s_nop 1
  s_branch L_ret_40
L_slow_41:
  ds_read_b128 v[128:131], v7 offset:8192
  ds_read_b128 v[132:135], v7 offset:9216
  s_waitcnt lgkmcnt(0)
  v_mfma_f32_32x32x16_bf16 v[144:159], v[128:131], v[12:15], 0
  v_mfma_f32_32x32x16_bf16 v[144:159], v[132:135], v[16:19], v[144:159]
  s_nop 15
  v_max3_f32 v1, v144, v145, v146
  v_max3_f32 v1, v1, v147, v148
  v_max3_f32 v1, v1, v149, v150
  v_max3_f32 v1, v1, v151, v152
  v_max3_f32 v1, v1, v153, v154
  v_max3_f32 v1, v1, v155, v156
  v_max3_f32 v1, v1, v157, v158
  v_max_f32 v1, v1, v159
  v_mov_b32 v2, v1
  s_nop 1
  v_permlane32_swap_b32 v1, v2
  s_nop 1
  v_max_f32 v1, v1, v2
  v_add_f32 v1, 0x42b40000, v1
  v_max_f32 v1, v1, v9
  v_sub_f32 v2, v9, v1
  v_mul_f32 v2, 0.5, v2
  v_exp_f32 v2, v2
  v_mov_b32 v9, v1
  v_sub_f32 v3, 0, v1
  v_mul_f32 v112, v112, v2
  v_mov_b32 v64, v3
  v_mul_f32 v112, v112, v2
  v_sub_f32 v144, v144, v1
  v_mul_f32 v113, v113, v2
  v_mov_b32 v65, v3
  v_mul_f32 v113, v113, v2
  v_sub_f32 v145, v145, v1
  v_mul_f32 v114, v114, v2
  v_mov_b32 v66, v3
  v_mul_f32 v114, v114, v2
  v_sub_f32 v146, v146, v1
  v_mul_f32 v115, v115, v2
  v_mov_b32 v67, v3
  v_mul_f32 v115, v115, v2
  v_sub_f32 v147, v147, v1
  v_mul_f32 v116, v116, v2
  v_mov_b32 v68, v3
  v_mul_f32 v116, v116, v2
  v_sub_f32 v148, v148, v1
  v_mul_f32 v117, v117, v2
  v_mov_b32 v69, v3
  v_mul_f32 v117, v117, v2
  v_sub_f32 v149, v149, v1
  v_mul_f32 v118, v118, v2
  v_mov_b32 v70, v3
  v_mul_f32 v118, v118, v2
  v_sub_f32 v150, v150, v1
  v_mul_f32 v119, v119, v2
  v_mov_b32 v71, v3
  v_mul_f32 v119, v119, v2
  v_sub_f32 v151, v151, v1
  v_mul_f32 v120, v120, v2
  v_mov_b32 v72, v3
  v_mul_f32 v120, v120, v2
  v_sub_f32 v152, v152, v1
  v_mul_f32 v121, v121, v2
  v_mov_b32 v73, v3
  v_mul_f32 v121, v121, v2
  v_sub_f32 v153, v153, v1
  v_mul_f32 v122, v122, v2
  v_mov_b32 v74, v3
  v_mul_f32 v122, v122, v2
  v_sub_f32 v154, v154, v1
  v_mul_f32 v123, v123, v2
  v_mov_b32 v75, v3
  v_mul_f32 v123, v123, v2
  v_sub_f32 v155, v155, v1
  v_mul_f32 v124, v124, v2
  v_mov_b32 v76, v3
  v_mul_f32 v124, v124, v2
  v_sub_f32 v156, v156, v1
  v_mul_f32 v125, v125, v2
  v_mov_b32 v77, v3
  v_mul_f32 v125, v125, v2
  v_sub_f32 v157, v157, v1
  v_mul_f32 v126, v126, v2
  v_mov_b32 v78, v3
  v_mul_f32 v126, v126, v2
  v_sub_f32 v158, v158, v1
  v_mul_f32 v127, v127, v2
  v_mov_b32 v79, v3
  v_mul_f32 v127, v127, v2
  v_sub_f32 v159, v159, v1
  v_mul_f32 v10, v10, v2
  v_mul_f32 v10, v10, v2
  v_exp_f32 v144, v144
  v_exp_f32 v145, v145
  v_exp_f32 v146, v146
  v_exp_f32 v147, v147
  v_exp_f32 v148, v148
  v_exp_f32 v149, v149
  v_exp_f32 v150, v150
  v_exp_f32 v151, v151
  v_exp_f32 v152, v152
  v_exp_f32 v153, v153
  v_exp_f32 v154, v154
  v_exp_f32 v155, v155
  v_exp_f32 v156, v156
  v_exp_f32 v157, v157
  v_exp_f32 v158, v158
  v_exp_f32 v159, v159
  s_nop 0
  v_cvt_pk_bf16_f32 v44, v144, v145
  v_cvt_pk_bf16_f32 v45, v146, v147
  v_cvt_pk_bf16_f32 v46, v148, v149
  v_cvt_pk_bf16_f32 v47, v150, v151
  v_cvt_pk_bf16_f32 v48, v152, v153
  v_cvt_pk_bf16_f32 v49, v154, v155
  v_cvt_pk_bf16_f32 v50, v156, v157
  v_cvt_pk_bf16_f32 v51, v158, v159
  s_nop 1
  v_mfma_f32_16x16x32_bf16 v[24:27], v[20:23], v[44:47], 0
  v_mfma_f32_16x16x32_bf16 v[24:27], v[20:23], v[48:51], v[24:27]
  ds_read_b128 v[128:131], v7 offset:12288
  ds_read_b128 v[132:135], v7 offset:13312
  s_waitcnt lgkmcnt(0)
  v_mfma_f32_32x32x16_bf16 v[96:111], v[128:131], v[12:15], v[64:79]
  v_mfma_f32_32x32x16_bf16 v[96:111], v[132:135], v[16:19], v[96:111]
  s_nop 7
  ds_read_b128 v[128:131], v8 offset:0
  ds_read_b128 v[132:135], v8 offset:1024
  s_waitcnt lgkmcnt(0)
  v_mfma_f32_32x32x16_bf16 v[80:95], v[128:131], v[12:15], v[64:79]
  v_mfma_f32_32x32x16_bf16 v[80:95], v[132:135], v[16:19], v[80:95]
  s_nop 15
  s_nop 0
  v_exp_f32 v96, v96
  s_nop 0
  v_exp_f32 v97, v97
  s_nop 0
  v_exp_f32 v98, v98
  s_nop 0
  v_exp_f32 v99, v99
  s_nop 0
  v_cvt_pk_bf16_f32 v52, v96, v97
  s_nop 0
  v_exp_f32 v100, v100
  s_nop 0
  v_exp_f32 v101, v101
  s_nop 0
  v_cvt_pk_bf16_f32 v53, v98, v99
  s_nop 0
  v_exp_f32 v102, v102
  s_nop 0
  v_exp_f32 v103, v103
  s_nop 0
  v_cvt_pk_bf16_f32 v54, v100, v101
  s_nop 1
  s_branch L_ret_42
L_slow_43:
  ds_read_b128 v[128:131], v6 offset:12288
  ds_read_b128 v[132:135], v6 offset:13312
  s_waitcnt lgkmcnt(0)
  v_mfma_f32_32x32x16_bf16 v[144:159], v[128:131], v[12:15], 0
  v_mfma_f32_32x32x16_bf16 v[144:159], v[132:135], v[16:19], v[144:159]
  s_nop 15
  v_max3_f32 v1, v144, v145, v146
  v_max3_f32 v1, v1, v147, v148
  v_max3_f32 v1, v1, v149, v150
  v_max3_f32 v1, v1, v151, v152
  v_max3_f32 v1, v1, v153, v154
  v_max3_f32 v1, v1, v155, v156
  v_max3_f32 v1, v1, v157, v158
  v_max_f32 v1, v1, v159
  v_mov_b32 v2, v1
  s_nop 1
  v_permlane32_swap_b32 v1, v2
  s_nop 1
  v_max_f32 v1, v1, v2
  v_add_f32 v1, 0x42b40000, v1
  v_max_f32 v1, v1, v9
  v_sub_f32 v2, v9, v1
  v_mul_f32 v2, 0.5, v2
  v_exp_f32 v2, v2
  v_mov_b32 v9, v1
  v_sub_f32 v3, 0, v1
  v_mul_f32 v112, v112, v2
  v_mov_b32 v64, v3
  v_mul_f32 v112, v112, v2
  v_sub_f32 v144, v144, v1
  v_mul_f32 v113, v113, v2
  v_mov_b32 v65, v3
  v_mul_f32 v113, v113, v2
  v_sub_f32 v145, v145, v1
  v_mul_f32 v114, v114, v2
  v_mov_b32 v66, v3
  v_mul_f32 v114, v114, v2
  v_sub_f32 v146, v146, v1
  v_mul_f32 v115, v115, v2
  v_mov_b32 v67, v3
  v_mul_f32 v115, v115, v2
  v_sub_f32 v147, v147, v1
  v_mul_f32 v116, v116, v2
  v_mov_b32 v68, v3
  v_mul_f32 v116, v116, v2
  v_sub_f32 v148, v148, v1
  v_mul_f32 v117, v117, v2
  v_mov_b32 v69, v3
  v_mul_f32 v117, v117, v2
  v_sub_f32 v149, v149, v1
  v_mul_f32 v118, v118, v2
  v_mov_b32 v70, v3
  v_mul_f32 v118, v118, v2
  v_sub_f32 v150, v150, v1
  v_mul_f32 v119, v119, v2
  v_mov_b32 v71, v3
  v_mul_f32 v119, v119, v2
  v_sub_f32 v151, v151, v1
  v_mul_f32 v120, v120, v2
  v_mov_b32 v72, v3
  v_mul_f32 v120, v120, v2
  v_sub_f32 v152, v152, v1
  v_mul_f32 v121, v121, v2
  v_mov_b32 v73, v3
  v_mul_f32 v121, v121, v2
  v_sub_f32 v153, v153, v1
  v_mul_f32 v122, v122, v2
  v_mov_b32 v74, v3
  v_mul_f32 v122, v122, v2
  v_sub_f32 v154, v154, v1
  v_mul_f32 v123, v123, v2
  v_mov_b32 v75, v3
  v_mul_f32 v123, v123, v2
  v_sub_f32 v155, v155, v1
  v_mul_f32 v124, v124, v2
  v_mov_b32 v76, v3
  v_mul_f32 v124, v124, v2
  v_sub_f32 v156, v156, v1
  v_mul_f32 v125, v125, v2
  v_mov_b32 v77, v3
  v_mul_f32 v125, v125, v2
  v_sub_f32 v157, v157, v1
  v_mul_f32 v126, v126, v2
  v_mov_b32 v78, v3
  v_mul_f32 v126, v126, v2
  v_sub_f32 v158, v158, v1
  v_mul_f32 v127, v127, v2
  v_mov_b32 v79, v3
  v_mul_f32 v127, v127, v2
  v_sub_f32 v159, v159, v1
  v_mul_f32 v10, v10, v2
  v_mul_f32 v10, v10, v2
  v_exp_f32 v144, v144
  v_exp_f32 v145, v145
  v_exp_f32 v146, v146
  v_exp_f32 v147, v147
  v_exp_f32 v148, v148
  v_exp_f32 v149, v149
  v_exp_f32 v150, v150
  v_exp_f32 v151, v151
  v_exp_f32 v152, v152
  v_exp_f32 v153, v153
  v_exp_f32 v154, v154
  v_exp_f32 v155, v155
  v_exp_f32 v156, v156
  v_exp_f32 v157, v157
  v_exp_f32 v158, v158
  v_exp_f32 v159, v159
  s_nop 0
  v_cvt_pk_bf16_f32 v52, v144, v145
  v_cvt_pk_bf16_f32 v53, v146, v147
  v_cvt_pk_bf16_f32 v54, v148, v149
  v_cvt_pk_bf16_f32 v55, v150, v151
  v_cvt_pk_bf16_f32 v56, v152, v153
  v_cvt_pk_bf16_f32 v57, v154, v155
  v_cvt_pk_bf16_f32 v58, v156, v157
  v_cvt_pk_bf16_f32 v59, v158, v159
  s_nop 1
  v_mfma_f32_16x16x32_bf16 v[24:27], v[20:23], v[52:55], 0
  v_mfma_f32_16x16x32_bf16 v[24:27], v[20:23], v[56:59], v[24:27]
  s_nop 15
  s_nop 1
  s_branch L_ret_44
.section .rodata,"a"
.p2align 6
.amdhsa_kernel attn_kernel
  .amdhsa_next_free_vgpr 168
  .amdhsa_next_free_sgpr 102
  .amdhsa_accum_offset 168
  .amdhsa_group_segment_fixed_size 0
  .amdhsa_kernarg_size 104
  .amdhsa_user_sgpr_count 2
  .amdhsa_user_sgpr_kernarg_segment_ptr 1
  .amdhsa_system_sgpr_workgroup_id_x 1
.end_amdhsa_kernel
.text
.globl outp_kernel
.p2align 8
.type outp_kernel,@function
outp_kernel:
  s_cmp_ge_u32 s2, 256
  s_cbranch_scc1 L_end_49
  s_load_dwordx2 s[6:7], s[0:1], 32
  s_load_dwordx2 s[12:13], s[0:1], 80
  s_load_dwordx2 s[14:15], s[0:1], 96
  s_load_dwordx4 s[8:11], s[0:1], 48
  s_and_b32 s46, s2, 7
  s_lshr_b32 s45, s2, 3
  s_lshl_b32 s40, s46, 1
  s_lshr_b32 s47, s45, 4
  s_add_u32 s40, s40, s47
  s_and_b32 s41, s45, 15
  v_lshrrev_b32 v1, 6, v0
  v_and_b32 v4, 63, v0
  v_readfirstlane_b32 s42, v1
  s_cmp_lt_u32 s42, 4
  s_cselect_b32 s47, 1, 0
  s_and_b32 s42, s42, 3
  s_lshr_b32 s43, s42, 1
  s_and_b32 s44, s42, 1
  v_lshlrev_b32 v8, 4, v4
  s_lshr_b32 s48, s46, 2
  s_and_b32 s51, s46, 1
  s_sub_u32 s52, 5, s51
  s_mov_b32 s66, 0x40000001
  s_cmp_eq_u32 s51, 0
  s_cselect_b32 s66, 0x33333334, s66
  s_mul_hi_u32 s49, s45, s66
  s_mul_i32 s66, s49, s52
  s_sub_u32 s50, s45, s66
  s_mul_i32 s51, s51, 5
  s_add_u32 s50, s50, s51
  s_bfe_u32 s51, s46, 0x10001
  s_sub_u32 s52, 5, s51
  s_cmp_lt_u32 s49, s52
  s_cselect_b32 s60, 1, 0
  s_mul_i32 s51, s51, 5
  s_add_u32 s49, s49, s51
  s_cmp_lg_u32 s47, 0
  s_cbranch_scc1 L_comp_50
  s_mov_b32 s68, 0
  v_add_u32 v9, 1024, v8
  v_add_u32 v10, 2048, v8
  v_add_u32 v11, 3072, v8
  v_bfe_u32 v1, v4, 4, 1
  v_lshlrev_b32 v1, 2, v1
  v_and_b32 v2, 7, v4
  v_xor_b32 v1, v1, v2
  v_lshlrev_b32 v1, 4, v1
  v_lshrrev_b32 v2, 3, v4
  v_lshl_add_u32 v136, v2, 11, v1
  v_add_u32 v137, 16384, v136
  v_add_u32 v138, 32768, v136
  v_add_u32 v139, 49152, v136
  v_add_u32 v140, 65536, v136
  v_add_u32 v141, 81920, v136
  v_add_u32 v142, 98304, v136
  v_add_u32 v143, 114688, v136
  s_lshl_b32 s59, s41, 7
  s_lshl_b32 s66, s42, 17
  s_add_u32 s59, s59, s66
  s_lshl_b32 s61, s42, 12
  s_lshl_b32 s62, s42, 13
  s_waitcnt lgkmcnt(0)
  s_mov_b32 s20, s6
  s_mov_b32 s21, s7
  s_mov_b32 s22, 2097152
  s_mov_b32 s23, 0x20000
  s_mov_b32 s32, s14
  s_mov_b32 s33, s15
  s_mov_b32 s34, 268435456
  s_mov_b32 s35, 0x20000
  s_mov_b32 s64, 0
  s_lshl_b32 s66, s68, 19
  s_add_u32 s66, s66, s59
  s_add_u32 s67, s62, s64
  s_add_u32 m0, s67, 0
  s_nop 0
  buffer_load_dwordx4 v136, s[20:23], s66 offen lds
  s_add_u32 m0, s67, 1024
  s_nop 0
  buffer_load_dwordx4 v137, s[20:23], s66 offen lds
  s_add_u32 m0, s67, 2048
  s_nop 0
  buffer_load_dwordx4 v138, s[20:23], s66 offen lds
  s_add_u32 m0, s67, 3072
  s_nop 0
  buffer_load_dwordx4 v139, s[20:23], s66 offen lds
  s_add_u32 m0, s67, 4096
  s_nop 0
  buffer_load_dwordx4 v140, s[20:23], s66 offen lds
  s_add_u32 m0, s67, 5120
  s_nop 0
  buffer_load_dwordx4 v141, s[20:23], s66 offen lds
  s_add_u32 m0, s67, 6144
  s_nop 0
  buffer_load_dwordx4 v142, s[20:23], s66 offen lds
  s_add_u32 m0, s67, 7168
  s_nop 0
  buffer_load_dwordx4 v143, s[20:23], s66 offen lds
  s_add_u32 s68, s68, 1
  s_and_b32 s68, s68, 3
  s_add_u32 s64, s64, 32768
  s_cmp_eq_u32 s64, 163840
  s_cselect_b32 s64, 0, s64
  s_lshl_b32 s66, s68, 19
  s_add_u32 s66, s66, s59
  s_add_u32 s67, s62, s64
  s_add_u32 m0, s67, 0
  s_nop 0
  buffer_load_dwordx4 v136, s[20:23], s66 offen lds
  s_add_u32 m0, s67, 1024
  s_nop 0
  buffer_load_dwordx4 v137, s[20:23], s66 offen lds
  s_add_u32 m0, s67, 2048
  s_nop 0
  buffer_load_dwordx4 v138, s[20:23], s66 offen lds
  s_add_u32 m0, s67, 3072
  s_nop 0
  buffer_load_dwordx4 v139, s[20:23], s66 offen lds
  s_add_u32 m0, s67, 4096
  s_nop 0
  buffer_load_dwordx4 v140, s[20:23], s66 offen lds
  s_add_u32 m0, s67, 5120
  s_nop 0
  buffer_load_dwordx4 v141, s[20:23], s66 offen lds
  s_add_u32 m0, s67, 6144
  s_nop 0
  buffer_load_dwordx4 v142, s[20:23], s66 offen lds
  s_add_u32 m0, s67, 7168
  s_nop 0
  buffer_load_dwordx4 v143, s[20:23], s66 offen lds
  s_add_u32 s68, s68, 1
  s_and_b32 s68, s68, 3
  s_add_u32 s64, s64, 32768
  s_cmp_eq_u32 s64, 163840
  s_cselect_b32 s64, 0, s64
  s_cmp_lt_u32 s42, 2
  s_cselect_b32 s16, s8, s10
  s_cselect_b32 s17, s9, s11
  s_mov_b32 s18, 8388608
  s_mov_b32 s19, 0x20000
  v_lshrrev_b32 v1, 4, v4
  v_and_b32 v2, 7, v4
  v_xor_b32 v1, v1, v2
  v_lshlrev_b32 v1, 4, v1
  v_lshrrev_b32 v2, 3, v4
  v_lshl_add_u32 v152, v2, 13, v1
  v_lshrrev_b32 v1, 4, v4
  v_add_u32 v1, 4, v1
  v_and_b32 v2, 7, v4
  v_xor_b32 v1, v1, v2
  v_lshlrev_b32 v1, 4, v1
  v_lshrrev_b32 v2, 3, v4
  v_lshl_add_u32 v153, v2, 13, v1
  v_add_u32 v153, 65536, v153
  v_lshrrev_b32 v1, 4, v4
  v_and_b32 v2, 7, v4
  v_xor_b32 v1, v1, v2
  v_lshlrev_b32 v1, 4, v1
  v_lshrrev_b32 v2, 3, v4
  v_lshl_add_u32 v154, v2, 13, v1
  v_add_u32 v154, 131072, v154
  v_lshrrev_b32 v1, 4, v4
  v_add_u32 v1, 4, v1
  v_and_b32 v2, 7, v4
  v_xor_b32 v1, v1, v2
  v_lshlrev_b32 v1, 4, v1
  v_lshrrev_b32 v2, 3, v4
  v_lshl_add_u32 v155, v2, 13, v1
  v_add_u32 v155, 196608, v155
  s_lshl_b32 s53, s49, 1
  s_add_u32 s53, s53, s44
  s_lshl_b32 s53, s53, 18
  s_lshl_b32 s66, s48, 12
  s_add_u32 s53, s53, s66
  s_lshl_b32 s54, s43, 2
  s_lshl_b32 s66, s48, 1
  s_add_u32 s54, s54, s66
  s_add_u32 s54, s54, s44
  s_mul_i32 s54, s54, 331776
  s_mul_i32 s66, s50, 36864
  s_add_u32 s54, s54, s66
  s_add_u32 s54, s54, 14680064
  s_add_u32 s69, s50, s49
  s_sub_u32 s66, s69, 9
  s_cmp_ge_u32 s69, 9
  s_cselect_b32 s69, s66, s69
  s_waitcnt vmcnt(8)
  s_barrier
  s_lshl_b32 s66, s68, 19
  s_add_u32 s66, s66, s59
  s_add_u32 s67, s62, s64
  s_add_u32 m0, s67, 0
  s_nop 0
  buffer_load_dwordx4 v136, s[20:23], s66 offen lds
  s_add_u32 m0, s67, 1024
  s_nop 0
  buffer_load_dwordx4 v137, s[20:23], s66 offen lds
  s_add_u32 m0, s67, 2048
  s_nop 0
  buffer_load_dwordx4 v138, s[20:23], s66 offen lds
  s_add_u32 m0, s67, 3072
  s_nop 0
  buffer_load_dwordx4 v139, s[20:23], s66 offen lds
  s_add_u32 m0, s67, 4096
  s_nop 0
  buffer_load_dwordx4 v140, s[20:23], s66 offen lds
  s_add_u32 m0, s67, 5120
  s_nop 0
  buffer_load_dwordx4 v141, s[20:23], s66 offen lds
  s_add_u32 m0, s67, 6144
  s_nop 0
  buffer_load_dwordx4 v142, s[20:23], s66 offen lds
  s_add_u32 m0, s67, 7168
  s_nop 0
  buffer_load_dwordx4 v143, s[20:23], s66 offen lds
  s_add_u32 s68, s68, 1
  s_and_b32 s68, s68, 3
  s_add_u32 s64, s64, 32768
  s_cmp_eq_u32 s64, 163840
  s_cselect_b32 s64, 0, s64
  s_waitcnt vmcnt(8)
  s_barrier
  s_lshl_b32 s66, s68, 19
  s_add_u32 s66, s66, s59
  s_add_u32 s67, s62, s64
  s_add_u32 m0, s67, 0
  s_nop 0
  buffer_load_dwordx4 v136, s[20:23], s66 offen lds
  s_add_u32 m0, s67, 1024
  s_nop 0
  buffer_load_dwordx4 v137, s[20:23], s66 offen lds
  s_add_u32 m0, s67, 2048
  s_nop 0
  buffer_load_dwordx4 v138, s[20:23], s66 offen lds
  s_add_u32 m0, s67, 3072
  s_nop 0
  buffer_load_dwordx4 v139, s[20:23], s66 offen lds
  s_add_u32 m0, s67, 4096
  s_nop 0
  buffer_load_dwordx4 v140, s[20:23], s66 offen lds
  s_add_u32 m0, s67, 5120
  s_nop 0
  buffer_load_dwordx4 v141, s[20:23], s66 offen lds
  s_add_u32 m0, s67, 6144
  s_nop 0
  buffer_load_dwordx4 v142, s[20:23], s66 offen lds
  s_add_u32 m0, s67, 7168
  s_nop 0
  buffer_load_dwordx4 v143, s[20:23], s66 offen lds
  s_add_u32 s68, s68, 1
  s_and_b32 s68, s68, 3
  s_add_u32 s64, s64, 32768
  s_cmp_eq_u32 s64, 163840
  s_cselect_b32 s64, 0, s64
  s_cmp_eq_u32 s60, 0
  s_cbranch_scc1 L_ltail_51
  s_lshl_b32 s66, s69, 7
  s_add_u32 s66, s66, s53
  s_add_u32 s67, s61, s64
  s_add_u32 m0, s67, 0
  s_nop 0
  buffer_load_dwordx4 v152, s[16:19], s66 offen lds
  s_add_u32 m0, s67, 1024
  s_nop 0
  buffer_load_dwordx4 v153, s[16:19], s66 offen lds
  s_add_u32 m0, s67, 2048
  s_nop 0
  buffer_load_dwordx4 v154, s[16:19], s66 offen lds
  s_add_u32 m0, s67, 3072
  s_nop 0
  buffer_load_dwordx4 v155, s[16:19], s66 offen lds
  s_lshl_b32 s66, s69, 12
  s_add_u32 s66, s66, s54
  s_add_u32 s67, s61, s64
  s_add_u32 m0, s67, 16384
  s_nop 0
  buffer_load_dwordx4 v8, s[32:35], s66 offen lds
  s_add_u32 m0, s67, 17408
  s_nop 0
  buffer_load_dwordx4 v9, s[32:35], s66 offen lds
  s_add_u32 m0, s67, 18432
  s_nop 0
  buffer_load_dwordx4 v10, s[32:35], s66 offen lds
  s_add_u32 m0, s67, 19456
  s_nop 0
  buffer_load_dwordx4 v11, s[32:35], s66 offen lds
  s_add_u32 s69, s69, 1
  s_cmp_eq_u32 s69, 9
  s_cselect_b32 s69, 0, s69
  s_add_u32 s64, s64, 32768
  s_cmp_eq_u32 s64, 163840
  s_cselect_b32 s64, 0, s64
  s_waitcnt vmcnt(16)
  s_barrier
  s_lshl_b32 s66, s69, 7
  s_add_u32 s66, s66, s53
  s_add_u32 s67, s61, s64
  s_add_u32 m0, s67, 0
  s_nop 0
  buffer_load_dwordx4 v152, s[16:19], s66 offen lds
  s_add_u32 m0, s67, 1024
  s_nop 0
  buffer_load_dwordx4 v153, s[16:19], s66 offen lds
  s_add_u32 m0, s67, 2048
  s_nop 0
  buffer_load_dwordx4 v154, s[16:19], s66 offen lds
  s_add_u32 m0, s67, 3072
  s_nop 0
  buffer_load_dwordx4 v155, s[16:19], s66 offen lds
  s_lshl_b32 s66, s69, 12
  s_add_u32 s66, s66, s54
  s_add_u32 s67, s61, s64
  s_add_u32 m0, s67, 16384
  s_nop 0
  buffer_load_dwordx4 v8, s[32:35], s66 offen lds
  s_add_u32 m0, s67, 17408
  s_nop 0
  buffer_load_dwordx4 v9, s[32:35], s66 offen lds
  s_add_u32 m0, s67, 18432
  s_nop 0
  buffer_load_dwordx4 v10, s[32:35], s66 offen lds
  s_add_u32 m0, s67, 19456
  s_nop 0
  buffer_load_dwordx4 v11, s[32:35], s66 offen lds
  s_add_u32 s69, s69, 1
  s_cmp_eq_u32 s69, 9
  s_cselect_b32 s69, 0, s69
  s_add_u32 s64, s64, 32768
  s_cmp_eq_u32 s64, 163840
  s_cselect_b32 s64, 0, s64
  s_waitcnt vmcnt(16)
  s_barrier
  s_lshl_b32 s66, s69, 7
  s_add_u32 s66, s66, s53
  s_add_u32 s67, s61, s64
  s_add_u32 m0, s67, 0
  s_nop 0
  buffer_load_dwordx4 v152, s[16:19], s66 offen lds
  s_add_u32 m0, s67, 1024
  s_nop 0
  buffer_load_dwordx4 v153, s[16:19], s66 offen lds
  s_add_u32 m0, s67, 2048
  s_nop 0
  buffer_load_dwordx4 v154, s[16:19], s66 offen lds
  s_add_u32 m0, s67, 3072
  s_nop 0
  buffer_load_dwordx4 v155, s[16:19], s66 offen lds
  s_lshl_b32 s66, s69, 12
  s_add_u32 s66, s66, s54
  s_add_u32 s67, s61, s64
  s_add_u32 m0, s67, 16384
  s_nop 0
  buffer_load_dwordx4 v8, s[32:35], s66 offen lds
  s_add_u32 m0, s67, 17408
  s_nop 0
  buffer_load_dwordx4 v9, s[32:35], s66 offen lds
  s_add_u32 m0, s67, 18432
  s_nop 0
  buffer_load_dwordx4 v10, s[32:35], s66 offen lds
  s_add_u32 m0, s67, 19456
  s_nop 0
  buffer_load_dwordx4 v11, s[32:35], s66 offen lds
  s_add_u32 s69, s69, 1
  s_cmp_eq_u32 s69, 9
  s_cselect_b32 s69, 0, s69
  s_add_u32 s64, s64, 32768
  s_cmp_eq_u32 s64, 163840
  s_cselect_b32 s64, 0, s64
  s_waitcnt vmcnt(16)
  s_barrier
  s_lshl_b32 s66, s69, 7
  s_add_u32 s66, s66, s53
  s_add_u32 s67, s61, s64
  s_add_u32 m0, s67, 0
  s_nop 0
  buffer_load_dwordx4 v152, s[16:19], s66 offen lds
  s_add_u32 m0, s67, 1024
  s_nop 0
  buffer_load_dwordx4 v153, s[16:19], s66 offen lds
  s_add_u32 m0, s67, 2048
  s_nop 0
  buffer_load_dwordx4 v154, s[16:19], s66 offen lds
  s_add_u32 m0, s67, 3072
  s_nop 0
  buffer_load_dwordx4 v155, s[16:19], s66 offen lds
  s_lshl_b32 s66, s69, 12
  s_add_u32 s66, s66, s54
  s_add_u32 s67, s61, s64
  s_add_u32 m0, s67, 16384
  s_nop 0
  buffer_load_dwordx4 v8, s[32:35], s66 offen lds
  s_add_u32 m0, s67, 17408
  s_nop 0
  buffer_load_dwordx4 v9, s[32:35], s66 offen lds
  s_add_u32 m0, s67, 18432
  s_nop 0
  buffer_load_dwordx4 v10, s[32:35], s66 offen lds
  s_add_u32 m0, s67, 19456
  s_nop 0
  buffer_load_dwordx4 v11, s[32:35], s66 offen lds
  s_add_u32 s69, s69, 1
  s_cmp_eq_u32 s69, 9
  s_cselect_b32 s69, 0, s69
  s_add_u32 s64, s64, 32768
  s_cmp_eq_u32 s64, 163840
  s_cselect_b32 s64, 0, s64
  s_barrier
  s_mov_b32 s65, 0
L_ll_52:
  s_waitcnt vmcnt(16)
  s_barrier
  s_lshl_b32 s66, s69, 7
  s_add_u32 s66, s66, s53
  s_add_u32 s67, s61, s64
  s_add_u32 m0, s67, 0
  s_nop 0
  buffer_load_dwordx4 v152, s[16:19], s66 offen lds
  s_add_u32 m0, s67, 1024
  s_nop 0
  buffer_load_dwordx4 v153, s[16:19], s66 offen lds
  s_add_u32 m0, s67, 2048
  s_nop 0
  buffer_load_dwordx4 v154, s[16:19], s66 offen lds
  s_add_u32 m0, s67, 3072
  s_nop 0
  buffer_load_dwordx4 v155, s[16:19], s66 offen lds
  s_lshl_b32 s66, s69, 12
  s_add_u32 s66, s66, s54
  s_add_u32 s67, s61, s64
  s_add_u32 m0, s67, 16384
  s_nop 0
  buffer_load_dwordx4 v8, s[32:35], s66 offen lds
  s_add_u32 m0, s67, 17408
  s_nop 0
  buffer_load_dwordx4 v9, s[32:35], s66 offen lds
  s_add_u32 m0, s67, 18432
  s_nop 0
  buffer_load_dwordx4 v10, s[32:35], s66 offen lds
  s_add_u32 m0, s67, 19456
  s_nop 0
  buffer_load_dwordx4 v11, s[32:35], s66 offen lds
  s_add_u32 s69, s69, 1
  s_cmp_eq_u32 s69, 9
  s_cselect_b32 s69, 0, s69
  s_add_u32 s64, s64, 32768
  s_cmp_eq_u32 s64, 163840
  s_cselect_b32 s64, 0, s64
  s_add_u32 s65, s65, 1
  s_cmp_lt_u32 s65, 5
  s_cbranch_scc1 L_ll_52
  s_waitcnt vmcnt(16)
  s_barrier
  s_waitcnt vmcnt(8)
  s_barrier
  s_waitcnt vmcnt(0)
  s_barrier
  s_branch L_end_49
L_ltail_51:
  s_waitcnt vmcnt(8)
  s_barrier
  s_waitcnt vmcnt(0)
  s_barrier
  s_branch L_end_49
L_comp_50:
  s_mov_b32 s56, 0
  v_bfe_u32 v1, v4, 2, 2
  v_lshrrev_b32 v2, 5, v4
  v_lshl_add_u32 v2, v2, 2, v1
  v_lshlrev_b32 v2, 7, v2
  v_lshrrev_b32 v1, 1, v1
  v_xor_b32 v1, s56, v1
  v_lshl_add_u32 v2, v1, 6, v2
  v_bfe_u32 v1, v4, 4, 1
  v_lshl_add_u32 v2, v1, 5, v2
  v_and_b32 v1, 3, v4
  v_lshl_add_u32 v16, v1, 3, v2
  v_xor_b32 v17, 64, v16
  v_bfe_u32 v1, v4, 1, 3
  v_lshrrev_b32 v2, 5, v4
  v_xor_b32 v1, v1, v2
  v_lshlrev_b32 v1, 4, v1
  v_and_b32 v2, 31, v4
  v_lshl_add_u32 v5, v2, 7, v1
  s_lshl_b32 s66, s43, 12
  v_add_u32 v5, s66, v5
  v_xor_b32 v18, 0, v5
  v_xor_b32 v19, 32, v5
  v_xor_b32 v20, 64, v5
  v_xor_b32 v21, 96, v5
  s_lshl_b32 s66, s44, 12
  v_add_u32 v22, s66, v8
  s_cmp_eq_u32 s60, 0
  s_cselect_b32 s55, 3, 99
  s_lshl_b32 s58, s40, 2
  s_add_u32 s58, s58, s42
  s_lshl_b32 s58, s58, 16
  s_add_u32 s58, s58, 5242880
  s_waitcnt lgkmcnt(0)
  s_mov_b32 s28, s12
  s_mov_b32 s29, s13
  s_mov_b32 s30, 8388608
  s_mov_b32 s31, 0x20000
  s_mov_b32 s32, s14
  s_mov_b32 s33, s15
  s_mov_b32 s34, 9437184
  s_mov_b32 s35, 0x20000
  s_add_u32 s34, s58, 65536
  buffer_load_dwordx4 v[136:139], v8, s[32:35], s58 offen offset:0
  buffer_load_dwordx4 v[140:143], v8, s[32:35], s58 offen offset:1024
  buffer_load_dwordx4 v[144:147], v8, s[32:35], s58 offen offset:2048
  buffer_load_dwordx4 v[148:151], v8, s[32:35], s58 offen offset:3072
  s_add_u32 s58, s58, 4096
  buffer_load_dwordx4 v[152:155], v8, s[32:35], s58 offen offset:0
  buffer_load_dwordx4 v[156:159], v8, s[32:35], s58 offen offset:1024
  buffer_load_dwordx4 v[160:163], v8, s[32:35], s58 offen offset:2048
  buffer_load_dwordx4 v[164:167], v8, s[32:35], s58 offen offset:3072
  s_add_u32 s58, s58, 4096
  buffer_load_dwordx4 v[168:171], v8, s[32:35], s58 offen offset:0
  buffer_load_dwordx4 v[172:175], v8, s[32:35], s58 offen offset:1024
  buffer_load_dwordx4 v[176:179], v8, s[32:35], s58 offen offset:2048
  v_mov_b32 v104, 0
  v_mov_b32 v105, 0
  v_mov_b32 v106, 0
  v_mov_b32 v107, 0
  v_mov_b32 v108, 0
  v_mov_b32 v109, 0
  v_mov_b32 v110, 0
  v_mov_b32 v111, 0
  v_mov_b32 v112, 0
  v_mov_b32 v113, 0
  v_mov_b32 v114, 0
  v_mov_b32 v115, 0
  v_mov_b32 v116, 0
  v_mov_b32 v117, 0
  v_mov_b32 v118, 0
  v_mov_b32 v119, 0
  v_mov_b32 v120, 0
  v_mov_b32 v121, 0
  v_mov_b32 v122, 0
  v_mov_b32 v123, 0
  v_mov_b32 v124, 0
  v_mov_b32 v125, 0
  v_mov_b32 v126, 0
  v_mov_b32 v127, 0
  v_mov_b32 v128, 0
  v_mov_b32 v129, 0
  v_mov_b32 v130, 0
  v_mov_b32 v131, 0
  v_mov_b32 v132, 0
  v_mov_b32 v133, 0
  v_mov_b32 v134, 0
  v_mov_b32 v135, 0
  s_mov_b32 s64, 0
  v_add_u32 v26, s64, v16
  v_add_u32 v27, s64, v17
  s_mov_b32 s65, 0
  s_barrier
  ds_read_b64_tr_b16 v[40:41], v26 offset:0
  ds_read_b64_tr_b16 v[42:43], v26 offset:1024
  ds_read_b64_tr_b16 v[44:45], v27 offset:0
  ds_read_b64_tr_b16 v[46:47], v27 offset:1024
  ds_read_b64_tr_b16 v[48:49], v26 offset:2048
  ds_read_b64_tr_b16 v[50:51], v26 offset:3072
  ds_read_b64_tr_b16 v[52:53], v27 offset:2048
  ds_read_b64_tr_b16 v[54:55], v27 offset:3072
  ds_read_b64_tr_b16 v[56:57], v26 offset:4096
  ds_read_b64_tr_b16 v[58:59], v26 offset:5120
  ds_read_b64_tr_b16 v[60:61], v27 offset:4096
  ds_read_b64_tr_b16 v[62:63], v27 offset:5120
L_ol_53:
  s_add_u32 s64, s64, 32768
  s_cmp_eq_u32 s64, 163840
  s_cselect_b32 s64, 0, s64
  s_cmp_eq_u32 s65, s55
  s_cbranch_scc1 L_onb_54
  s_barrier
L_onb_54:
  s_waitcnt vmcnt(10) lgkmcnt(8)
  v_mfma_f32_32x32x16_bf16 v[104:119], v[40:43], v[136:139], v[104:119]
  ds_read_b64_tr_b16 v[64:65], v26 offset:6144
  ds_read_b64_tr_b16 v[66:67], v26 offset:7168
  buffer_load_dwordx4 v[180:183], v8, s[32:35], s58 offen offset:3072
  s_add_u32 s58, s58, 4096
  v_mfma_f32_32x32x16_bf16 v[120:135], v[44:47], v[136:139], v[120:135]
  ds_read_b64_tr_b16 v[68:69], v27 offset:6144
  ds_read_b64_tr_b16 v[70:71], v27 offset:7168
  s_waitcnt vmcnt(10) lgkmcnt(8)
  v_mfma_f32_32x32x16_bf16 v[104:119], v[48:51], v[140:143], v[104:119]
  ds_read_b64_tr_b16 v[40:41], v26 offset:8192
  ds_read_b64_tr_b16 v[42:43], v26 offset:9216
  buffer_load_dwordx4 v[184:187], v8, s[32:35], s58 offen offset:0
  v_mfma_f32_32x32x16_bf16 v[120:135], v[52:55], v[140:143], v[120:135]
  ds_read_b64_tr_b16 v[44:45], v27 offset:8192
  ds_read_b64_tr_b16 v[46:47], v27 offset:9216
  s_waitcnt vmcnt(10) lgkmcnt(8)
  v_mfma_f32_32x32x16_bf16 v[104:119], v[56:59], v[144:147], v[104:119]
  ds_read_b64_tr_b16 v[48:49], v26 offset:10240
  ds_read_b64_tr_b16 v[50:51], v26 offset:11264
  buffer_load_dwordx4 v[188:191], v8, s[32:35], s58 offen offset:1024
  v_mfma_f32_32x32x16_bf16 v[120:135], v[60:63], v[144:147], v[120:135]
  ds_read_b64_tr_b16 v[52:53], v27 offset:10240
  ds_read_b64_tr_b16 v[54:55], v27 offset:11264
  s_waitcnt vmcnt(10) lgkmcnt(8)
  v_mfma_f32_32x32x16_bf16 v[104:119], v[64:67], v[148:151], v[104:119]
  ds_read_b64_tr_b16 v[56:57], v26 offset:12288
  ds_read_b64_tr_b16 v[58:59], v26 offset:13312
  buffer_load_dwordx4 v[192:195], v8, s[32:35], s58 offen offset:2048
  v_mfma_f32_32x32x16_bf16 v[120:135], v[68:71], v[148:151], v[120:135]
  ds_read_b64_tr_b16 v[60:61], v27 offset:12288
  ds_read_b64_tr_b16 v[62:63], v27 offset:13312
  s_waitcnt vmcnt(10) lgkmcnt(8)
  v_mfma_f32_32x32x16_bf16 v[104:119], v[40:43], v[152:155], v[104:119]
  ds_read_b64_tr_b16 v[64:65], v26 offset:14336
  ds_read_b64_tr_b16 v[66:67], v26 offset:15360
  buffer_load_dwordx4 v[196:199], v8, s[32:35], s58 offen offset:3072
  s_add_u32 s58, s58, 4096
  v_mfma_f32_32x32x16_bf16 v[120:135], v[44:47], v[152:155], v[120:135]
  ds_read_b64_tr_b16 v[68:69], v27 offset:14336
  ds_read_b64_tr_b16 v[70:71], v27 offset:15360
  s_waitcnt vmcnt(10) lgkmcnt(8)
  v_mfma_f32_32x32x16_bf16 v[104:119], v[48:51], v[156:159], v[104:119]
  ds_read_b64_tr_b16 v[40:41], v26 offset:16384
  ds_read_b64_tr_b16 v[42:43], v26 offset:17408
  buffer_load_dwordx4 v[136:139], v8, s[32:35], s58 offen offset:0
  v_mfma_f32_32x32x16_bf16 v[120:135], v[52:55], v[156:159], v[120:135]
  ds_read_b64_tr_b16 v[44:45], v27 offset:16384
  ds_read_b64_tr_b16 v[46:47], v27 offset:17408
  s_waitcnt vmcnt(10) lgkmcnt(8)
  v_mfma_f32_32x32x16_bf16 v[104:119], v[56:59], v[160:163], v[104:119]
  ds_read_b64_tr_b16 v[48:49], v26 offset:18432
  ds_read_b64_tr_b16 v[50:51], v26 offset:19456
  buffer_load_dwordx4 v[140:143], v8, s[32:35], s58 offen offset:1024
  v_mfma_f32_32x32x16_bf16 v[120:135], v[60:63], v[160:163], v[120:135]
  ds_read_b64_tr_b16 v[52:53], v27 offset:18432
  ds_read_b64_tr_b16 v[54:55], v27 offset:19456
  s_waitcnt vmcnt(10) lgkmcnt(8)
  v_mfma_f32_32x32x16_bf16 v[104:119], v[64:67], v[164:167], v[104:119]
  ds_read_b64_tr_b16 v[56:57], v26 offset:20480
  ds_read_b64_tr_b16 v[58:59], v26 offset:21504
  buffer_load_dwordx4 v[144:147], v8, s[32:35], s58 offen offset:2048
  v_mfma_f32_32x32x16_bf16 v[120:135], v[68:71], v[164:167], v[120:135]
  ds_read_b64_tr_b16 v[60:61], v27 offset:20480
  ds_read_b64_tr_b16 v[62:63], v27 offset:21504
  s_waitcnt vmcnt(10) lgkmcnt(8)
  v_mfma_f32_32x32x16_bf16 v[104:119], v[40:43], v[168:171], v[104:119]
  ds_read_b64_tr_b16 v[64:65], v26 offset:22528
  ds_read_b64_tr_b16 v[66:67], v26 offset:23552
  buffer_load_dwordx4 v[148:151], v8, s[32:35], s58 offen offset:3072
  s_add_u32 s58, s58, 4096
  v_mfma_f32_32x32x16_bf16 v[120:135], v[44:47], v[168:171], v[120:135]
  ds_read_b64_tr_b16 v[68:69], v27 offset:22528
  ds_read_b64_tr_b16 v[70:71], v27 offset:23552
  s_waitcnt vmcnt(10) lgkmcnt(8)
  v_mfma_f32_32x32x16_bf16 v[104:119], v[48:51], v[172:175], v[104:119]
  ds_read_b64_tr_b16 v[40:41], v26 offset:24576
  ds_read_b64_tr_b16 v[42:43], v26 offset:25600
  buffer_load_dwordx4 v[152:155], v8, s[32:35], s58 offen offset:0
  v_mfma_f32_32x32x16_bf16 v[120:135], v[52:55], v[172:175], v[120:135]
  ds_read_b64_tr_b16 v[44:45], v27 offset:24576
  ds_read_b64_tr_b16 v[46:47], v27 offset:25600
  s_waitcnt vmcnt(10) lgkmcnt(8)
  v_mfma_f32_32x32x16_bf16 v[104:119], v[56:59], v[176:179], v[104:119]
  ds_read_b64_tr_b16 v[48:49], v26 offset:26624
  ds_read_b64_tr_b16 v[50:51], v26 offset:27648
  buffer_load_dwordx4 v[156:159], v8, s[32:35], s58 offen offset:1024
  v_mfma_f32_32x32x16_bf16 v[120:135], v[60:63], v[176:179], v[120:135]
  ds_read_b64_tr_b16 v[52:53], v27 offset:26624
  ds_read_b64_tr_b16 v[54:55], v27 offset:27648
  s_waitcnt vmcnt(10) lgkmcnt(8)
  v_mfma_f32_32x32x16_bf16 v[104:119], v[64:67], v[180:183], v[104:119]
  ds_read_b64_tr_b16 v[56:57], v26 offset:28672
  ds_read_b64_tr_b16 v[58:59], v26 offset:29696
  buffer_load_dwordx4 v[160:163], v8, s[32:35], s58 offen offset:2048
  v_mfma_f32_32x32x16_bf16 v[120:135], v[68:71], v[180:183], v[120:135]
  ds_read_b64_tr_b16 v[60:61], v27 offset:28672
  ds_read_b64_tr_b16 v[62:63], v27 offset:29696
  s_waitcnt vmcnt(10) lgkmcnt(8)
  v_mfma_f32_32x32x16_bf16 v[104:119], v[40:43], v[184:187], v[104:119]
  ds_read_b64_tr_b16 v[64:65], v26 offset:30720
  ds_read_b64_tr_b16 v[66:67], v26 offset:31744
  buffer_load_dwordx4 v[164:167], v8, s[32:35], s58 offen offset:3072
  s_add_u32 s58, s58, 4096
  v_mfma_f32_32x32x16_bf16 v[120:135], v[44:47], v[184:187], v[120:135]
  ds_read_b64_tr_b16 v[68:69], v27 offset:30720
  ds_read_b64_tr_b16 v[70:71], v27 offset:31744
  v_add_u32 v26, s64, v16
  v_add_u32 v27, s64, v17
  s_waitcnt vmcnt(10) lgkmcnt(8)
  v_mfma_f32_32x32x16_bf16 v[104:119], v[48:51], v[188:191], v[104:119]
  ds_read_b64_tr_b16 v[40:41], v26 offset:0
  ds_read_b64_tr_b16 v[42:43], v26 offset:1024
  buffer_load_dwordx4 v[168:171], v8, s[32:35], s58 offen offset:0
  v_mfma_f32_32x32x16_bf16 v[120:135], v[52:55], v[188:191], v[120:135]
  ds_read_b64_tr_b16 v[44:45], v27 offset:0
  ds_read_b64_tr_b16 v[46:47], v27 offset:1024
  s_waitcnt vmcnt(10) lgkmcnt(8)
  v_mfma_f32_32x32x16_bf16 v[104:119], v[56:59], v[192:195], v[104:119]
  ds_read_b64_tr_b16 v[48:49], v26 offset:2048
  ds_read_b64_tr_b16 v[50:51], v26 offset:3072
  buffer_load_dwordx4 v[172:175], v8, s[32:35], s58 offen offset:1024
  v_mfma_f32_32x32x16_bf16 v[120:135], v[60:63], v[192:195], v[120:135]
  ds_read_b64_tr_b16 v[52:53], v27 offset:2048
  ds_read_b64_tr_b16 v[54:55], v27 offset:3072
  s_waitcnt vmcnt(10) lgkmcnt(8)
  v_mfma_f32_32x32x16_bf16 v[104:119], v[64:67], v[196:199], v[104:119]
  ds_read_b64_tr_b16 v[56:57], v26 offset:4096
  ds_read_b64_tr_b16 v[58:59], v26 offset:5120
  buffer_load_dwordx4 v[176:179], v8, s[32:35], s58 offen offset:2048
  v_mfma_f32_32x32x16_bf16 v[120:135], v[68:71], v[196:199], v[120:135]
  ds_read_b64_tr_b16 v[60:61], v27 offset:4096
  ds_read_b64_tr_b16 v[62:63], v27 offset:5120
  s_add_u32 s65, s65, 1
  s_cmp_lt_u32 s65, 4
  s_cbranch_scc1 L_ol_53
  s_waitcnt vmcnt(0) lgkmcnt(0)
  s_barrier
  v_and_b32 v1, 31, v4
  v_mul_u32_u24 v5, 144, v1
  v_lshrrev_b32 v1, 5, v4
  v_lshl_add_u32 v5, v1, 4, v5
  s_mul_i32 s56, s42, 4608
  s_add_u32 s56, s56, 98304
  v_add_u32 v5, s56, v5
  v_lshrrev_b32 v1, 3, v4
  v_and_b32 v2, 7, v4
  v_mul_u32_u24 v6, 144, v1
  v_lshl_add_u32 v6, v2, 4, v6
  v_add_u32 v6, s56, v6
  v_lshlrev_b32 v7, 12, v1
  v_lshl_add_u32 v7, v2, 4, v7
  s_lshl_b32 s56, s40, 2
  s_add_u32 s56, s56, s42
  s_lshl_b32 s56, s56, 17
  s_lshl_b32 s57, s41, 7
  s_add_u32 s56, s56, s57
  v_cvt_pk_bf16_f32 v136, v104, v105
  v_cvt_pk_bf16_f32 v137, v106, v107
  v_cvt_pk_bf16_f32 v138, v108, v109
  v_cvt_pk_bf16_f32 v139, v110, v111
  v_cvt_pk_bf16_f32 v140, v112, v113
  v_cvt_pk_bf16_f32 v141, v114, v115
  v_cvt_pk_bf16_f32 v142, v116, v117
  v_cvt_pk_bf16_f32 v143, v118, v119
  s_nop 1
  v_permlane32_swap_b32 v136, v138
  v_permlane32_swap_b32 v137, v139
  v_permlane32_swap_b32 v140, v142
  v_permlane32_swap_b32 v141, v143
  ds_write_b128 v5, v[136:139] offset:0
  ds_write_b128 v5, v[140:143] offset:32
  v_cvt_pk_bf16_f32 v144, v120, v121
  v_cvt_pk_bf16_f32 v145, v122, v123
  v_cvt_pk_bf16_f32 v146, v124, v125
  v_cvt_pk_bf16_f32 v147, v126, v127
  v_cvt_pk_bf16_f32 v148, v128, v129
  v_cvt_pk_bf16_f32 v149, v130, v131
  v_cvt_pk_bf16_f32 v150, v132, v133
  v_cvt_pk_bf16_f32 v151, v134, v135
  s_nop 1
  v_permlane32_swap_b32 v144, v146
  v_permlane32_swap_b32 v145, v147
  v_permlane32_swap_b32 v148, v150
  v_permlane32_swap_b32 v149, v151
  ds_write_b128 v5, v[144:147] offset:64
  ds_write_b128 v5, v[148:151] offset:96
  s_waitcnt lgkmcnt(0)
  ds_read_b128 v[152:155], v6 offset:0
  ds_read_b128 v[156:159], v6 offset:1152
  ds_read_b128 v[160:163], v6 offset:2304
  ds_read_b128 v[164:167], v6 offset:3456
  s_add_u32 s57, s56, 0
  s_waitcnt lgkmcnt(3)
  buffer_store_dwordx4 v[152:155], v7, s[28:31], s57 offen
  s_add_u32 s57, s56, 32768
  s_waitcnt lgkmcnt(2)
  buffer_store_dwordx4 v[156:159], v7, s[28:31], s57 offen
  s_add_u32 s57, s56, 65536
  s_waitcnt lgkmcnt(1)
  buffer_store_dwordx4 v[160:163], v7, s[28:31], s57 offen
  s_add_u32 s57, s56, 98304
  s_waitcnt lgkmcnt(0)
  buffer_store_dwordx4 v[164:167], v7, s[28:31], s57 offen
  s_cmp_eq_u32 s60, 0
  s_cbranch_scc1 L_fin_55
  v_mov_b32 v104, 0
  v_mov_b32 v105, 0
  v_mov_b32 v106, 0
  v_mov_b32 v107, 0
  v_mov_b32 v108, 0
  v_mov_b32 v109, 0
  v_mov_b32 v110, 0
  v_mov_b32 v111, 0
  v_mov_b32 v112, 0
  v_mov_b32 v113, 0
  v_mov_b32 v114, 0
  v_mov_b32 v115, 0
  v_mov_b32 v116, 0
  v_mov_b32 v117, 0
  v_mov_b32 v118, 0
  v_mov_b32 v119, 0
  v_mov_b32 v120, 0
  v_mov_b32 v121, 0
  v_mov_b32 v122, 0
  v_mov_b32 v123, 0
  v_mov_b32 v124, 0
  v_mov_b32 v125, 0
  v_mov_b32 v126, 0
  v_mov_b32 v127, 0
  v_mov_b32 v128, 0
  v_mov_b32 v129, 0
  v_mov_b32 v130, 0
  v_mov_b32 v131, 0
  v_mov_b32 v132, 0
  v_mov_b32 v133, 0
  v_mov_b32 v134, 0
  v_mov_b32 v135, 0
  v_add_u32 v26, s64, v18
  v_add_u32 v27, s64, v19
  v_add_u32 v28, s64, v20
  v_add_u32 v29, s64, v21
  v_add_u32 v30, s64, v22
  s_mov_b32 s65, 0
  ds_read_b128 v[40:43], v26 offset:0
  ds_read_b128 v[44:47], v26 offset:8192
  ds_read_b128 v[48:51], v30 offset:16384
  ds_read_b128 v[52:55], v30 offset:24576
  ds_read_b128 v[56:59], v27 offset:0
  ds_read_b128 v[60:63], v27 offset:8192
  ds_read_b128 v[64:67], v30 offset:17408
  ds_read_b128 v[68:71], v30 offset:25600
  ds_read_b128 v[72:75], v28 offset:0
  ds_read_b128 v[76:79], v28 offset:8192
  ds_read_b128 v[80:83], v30 offset:18432
  ds_read_b128 v[84:87], v30 offset:26624
L_gl_56:
  s_add_u32 s64, s64, 32768
  s_cmp_eq_u32 s64, 163840
  s_cselect_b32 s64, 0, s64
  s_cmp_eq_u32 s65, 8
  s_cbranch_scc1 L_gnb_57
  s_barrier
L_gnb_57:
  s_waitcnt lgkmcnt(8)
  v_mfma_f32_32x32x16_bf16 v[104:119], v[40:43], v[48:51], v[104:119]
  ds_read_b128 v[88:91], v29 offset:0
  ds_read_b128 v[92:95], v29 offset:8192
  v_mfma_f32_32x32x16_bf16 v[120:135], v[44:47], v[52:55], v[120:135]
  ds_read_b128 v[96:99], v30 offset:19456
  ds_read_b128 v[100:103], v30 offset:27648
  v_add_u32 v26, s64, v18
  v_add_u32 v27, s64, v19
  v_add_u32 v28, s64, v20
  v_add_u32 v29, s64, v21
  v_add_u32 v30, s64, v22
  s_waitcnt lgkmcnt(8)
  v_mfma_f32_32x32x16_bf16 v[104:119], v[56:59], v[64:67], v[104:119]
  ds_read_b128 v[40:43], v26 offset:0
  ds_read_b128 v[44:47], v26 offset:8192
  v_mfma_f32_32x32x16_bf16 v[120:135], v[60:63], v[68:71], v[120:135]
  ds_read_b128 v[48:51], v30 offset:16384
  ds_read_b128 v[52:55], v30 offset:24576
  s_waitcnt lgkmcnt(8)
  v_mfma_f32_32x32x16_bf16 v[104:119], v[72:75], v[80:83], v[104:119]
  ds_read_b128 v[56:59], v27 offset:0
  ds_read_b128 v[60:63], v27 offset:8192
  v_mfma_f32_32x32x16_bf16 v[120:135], v[76:79], v[84:87], v[120:135]
  ds_read_b128 v[64:67], v30 offset:17408
  ds_read_b128 v[68:71], v30 offset:25600
  s_waitcnt lgkmcnt(8)
  v_mfma_f32_32x32x16_bf16 v[104:119], v[88:91], v[96:99], v[104:119]
  ds_read_b128 v[72:75], v28 offset:0
  ds_read_b128 v[76:79], v28 offset:8192
  v_mfma_f32_32x32x16_bf16 v[120:135], v[92:95], v[100:103], v[120:135]
  ds_read_b128 v[80:83], v30 offset:18432
  ds_read_b128 v[84:87], v30 offset:26624
  s_add_u32 s65, s65, 1
  s_cmp_lt_u32 s65, 9
  s_cbranch_scc1 L_gl_56
  s_waitcnt lgkmcnt(0)
  s_nop 7
  s_barrier
  v_lshrrev_b32 v1, 5, v4
  s_lshl_b32 s66, s43, 5
  v_lshl_add_u32 v1, v1, 2, s66
  v_mul_u32_u24 v1, 144, v1
  v_and_b32 v2, 31, v4
  v_lshlrev_b32 v2, 2, v2
  s_lshl_b32 s66, s44, 1
  v_add_u32 v2, s66, v2
  v_add_u32 v5, v1, v2
  v_sub_u32 v6, v1, v2
  v_add_u32 v6, 128, v6
  v_sub_f32 v1, v104, v120
  v_add_f32 v3, v104, v120
  v_cvt_pk_bf16_f32 v104, v1, v3
  ds_write_b16 v5, v104 offset:0
  ds_write_b16_d16_hi v5, v104 offset:9216
  ds_write_b16_d16_hi v6, v104 offset:18432
  ds_write_b16 v6, v104 offset:27648
  v_sub_f32 v1, v105, v121
  v_add_f32 v3, v105, v121
  v_cvt_pk_bf16_f32 v105, v1, v3
  ds_write_b16 v5, v105 offset:144
  ds_write_b16_d16_hi v5, v105 offset:9360
  ds_write_b16_d16_hi v6, v105 offset:18576
  ds_write_b16 v6, v105 offset:27792
  v_sub_f32 v1, v106, v122
  v_add_f32 v3, v106, v122
  v_cvt_pk_bf16_f32 v106, v1, v3
  ds_write_b16 v5, v106 offset:288
  ds_write_b16_d16_hi v5, v106 offset:9504
  ds_write_b16_d16_hi v6, v106 offset:18720
  ds_write_b16 v6, v106 offset:27936
  v_sub_f32 v1, v107, v123
  v_add_f32 v3, v107, v123
  v_cvt_pk_bf16_f32 v107, v1, v3
  ds_write_b16 v5, v107 offset:432
  ds_write_b16_d16_hi v5, v107 offset:9648
  ds_write_b16_d16_hi v6, v107 offset:18864
  ds_write_b16 v6, v107 offset:28080
  v_sub_f32 v1, v108, v124
  v_add_f32 v3, v108, v124
  v_cvt_pk_bf16_f32 v108, v1, v3
  ds_write_b16 v5, v108 offset:1152
  ds_write_b16_d16_hi v5, v108 offset:10368
  ds_write_b16_d16_hi v6, v108 offset:19584
  ds_write_b16 v6, v108 offset:28800
  v_sub_f32 v1, v109, v125
  v_add_f32 v3, v109, v125
  v_cvt_pk_bf16_f32 v109, v1, v3
  ds_write_b16 v5, v109 offset:1296
  ds_write_b16_d16_hi v5, v109 offset:10512
  ds_write_b16_d16_hi v6, v109 offset:19728
  ds_write_b16 v6, v109 offset:28944
  v_sub_f32 v1, v110, v126
  v_add_f32 v3, v110, v126
  v_cvt_pk_bf16_f32 v110, v1, v3
  ds_write_b16 v5, v110 offset:1440
  ds_write_b16_d16_hi v5, v110 offset:10656
  ds_write_b16_d16_hi v6, v110 offset:19872
  ds_write_b16 v6, v110 offset:29088
  v_sub_f32 v1, v111, v127
  v_add_f32 v3, v111, v127
  v_cvt_pk_bf16_f32 v111, v1, v3
  ds_write_b16 v5, v111 offset:1584
  ds_write_b16_d16_hi v5, v111 offset:10800
  ds_write_b16_d16_hi v6, v111 offset:20016
  ds_write_b16 v6, v111 offset:29232
  v_sub_f32 v1, v112, v128
  v_add_f32 v3, v112, v128
  v_cvt_pk_bf16_f32 v112, v1, v3
  ds_write_b16 v5, v112 offset:2304
  ds_write_b16_d16_hi v5, v112 offset:11520
  ds_write_b16_d16_hi v6, v112 offset:20736
  ds_write_b16 v6, v112 offset:29952
  v_sub_f32 v1, v113, v129
  v_add_f32 v3, v113, v129
  v_cvt_pk_bf16_f32 v113, v1, v3
  ds_write_b16 v5, v113 offset:2448
  ds_write_b16_d16_hi v5, v113 offset:11664
  ds_write_b16_d16_hi v6, v113 offset:20880
  ds_write_b16 v6, v113 offset:30096
  v_sub_f32 v1, v114, v130
  v_add_f32 v3, v114, v130
  v_cvt_pk_bf16_f32 v114, v1, v3
  ds_write_b16 v5, v114 offset:2592
  ds_write_b16_d16_hi v5, v114 offset:11808
  ds_write_b16_d16_hi v6, v114 offset:21024
  ds_write_b16 v6, v114 offset:30240
  v_sub_f32 v1, v115, v131
  v_add_f32 v3, v115, v131
  v_cvt_pk_bf16_f32 v115, v1, v3
  ds_write_b16 v5, v115 offset:2736
  ds_write_b16_d16_hi v5, v115 offset:11952
  ds_write_b16_d16_hi v6, v115 offset:21168
  ds_write_b16 v6, v115 offset:30384
  v_sub_f32 v1, v116, v132
  v_add_f32 v3, v116, v132
  v_cvt_pk_bf16_f32 v116, v1, v3
  ds_write_b16 v5, v116 offset:3456
  ds_write_b16_d16_hi v5, v116 offset:12672
  ds_write_b16_d16_hi v6, v116 offset:21888
  ds_write_b16 v6, v116 offset:31104
  v_sub_f32 v1, v117, v133
  v_add_f32 v3, v117, v133
  v_cvt_pk_bf16_f32 v117, v1, v3
  ds_write_b16 v5, v117 offset:3600
  ds_write_b16_d16_hi v5, v117 offset:12816
  ds_write_b16_d16_hi v6, v117 offset:22032
  ds_write_b16 v6, v117 offset:31248
  v_sub_f32 v1, v118, v134
  v_add_f32 v3, v118, v134
  v_cvt_pk_bf16_f32 v118, v1, v3
  ds_write_b16 v5, v118 offset:3744
  ds_write_b16_d16_hi v5, v118 offset:12960
  ds_write_b16_d16_hi v6, v118 offset:22176
  ds_write_b16 v6, v118 offset:31392
  v_sub_f32 v1, v119, v135
  v_add_f32 v3, v119, v135
  v_cvt_pk_bf16_f32 v119, v1, v3
  ds_write_b16 v5, v119 offset:3888
  ds_write_b16_d16_hi v5, v119 offset:13104
  ds_write_b16_d16_hi v6, v119 offset:22320
  ds_write_b16 v6, v119 offset:31536
  v_lshrrev_b32 v7, 3, v4
  v_and_b32 v8, 7, v4
  v_mul_u32_u24 v9, 144, v7
  s_mul_i32 s66, s42, 9216
  v_add_u32 v9, s66, v9
  v_lshl_add_u32 v10, v8, 4, v9
  s_mov_b32 s68, 0x40000000
  v_mov_b32 v2, s68
  s_lshl_b32 s66, s50, 7
  s_add_u32 s67, s66, 2048
  s_sub_u32 s66, 3968, s66
  s_cmp_ge_u32 s42, 2
  s_cselect_b32 s66, s66, s67
  s_cselect_b32 s69, 1, 0
  v_lshl_add_u32 v11, v8, 4, s66
  v_cmp_le_u32 vcc, s69, v8
  s_cmp_lt_u32 s50, 8
  s_cselect_b64 s[70:71], vcc, 0
  s_nop 1
  v_cndmask_b32 v11, v2, v11, s[70:71]
  v_add_u32 v12, 1, v8
  v_cmp_eq_u32 vcc, 7, v8
  v_mov_b32 v1, 64
  s_nop 1
  v_cndmask_b32 v12, v12, v1, vcc
  v_mul_u32_u24 v12, s69, v12
  v_lshlrev_b32 v12, 1, v12
  v_add_u32 v13, v9, v12
  v_add_u32 v12, s66, v12
  s_not_b64 s[72:73], vcc
  s_cmp_eq_u32 s50, 0
  s_cselect_b64 s[72:73], s[72:73], -1
  s_cmp_lt_u32 s50, 8
  s_cselect_b64 s[72:73], s[72:73], 0
  v_cmp_eq_u32 vcc, 0, v8
  s_cmp_eq_u32 s50, 8
  s_cselect_b64 s[74:75], vcc, 0
  s_cmp_lg_u32 s69, 0
  s_cselect_b64 s[72:73], s[72:73], s[74:75]
  s_nop 1
  v_cndmask_b32 v12, v2, v12, s[72:73]
  s_lshl_b32 s66, s49, 7
  s_add_u32 s66, s66, s48
  v_lshl_add_u32 v7, v7, 1, s66
  s_and_b32 s67, s42, 1
  s_sub_u32 s74, 1024, s67
  s_waitcnt lgkmcnt(0)
  s_barrier
  ds_read_b128 v[104:107], v10 offset:0
  ds_read_b128 v[108:111], v10 offset:1152
  ds_read_b128 v[112:115], v10 offset:2304
  ds_read_b128 v[116:119], v10 offset:3456
  ds_read_b128 v[120:123], v10 offset:4608
  ds_read_b128 v[124:127], v10 offset:5760
  ds_read_b128 v[128:131], v10 offset:6912
  ds_read_b128 v[132:135], v10 offset:8064
  ds_read_u16 v40, v13 offset:0
  ds_read_u16 v41, v13 offset:1152
  ds_read_u16 v42, v13 offset:2304
  ds_read_u16 v43, v13 offset:3456
  ds_read_u16 v44, v13 offset:4608
  ds_read_u16 v45, v13 offset:5760
  ds_read_u16 v46, v13 offset:6912
  ds_read_u16 v47, v13 offset:8064
  v_add_u32 v1, 0, v7
  v_sub_u32 v3, 2048, v1
  s_cmp_lg_u32 s67, 0
  s_cselect_b64 vcc, -1, 0
  v_cmp_ge_u32 s[70:71], s74, v1
  v_cndmask_b32 v3, v1, v3, vcc
  v_lshlrev_b32 v3, 12, v3
  v_cndmask_b32 v48, v2, v3, s[70:71]
  v_add_u32 v1, 16, v7
  v_sub_u32 v3, 2048, v1
  s_cmp_lg_u32 s67, 0
  s_cselect_b64 vcc, -1, 0
  v_cmp_ge_u32 s[70:71], s74, v1
  v_cndmask_b32 v3, v1, v3, vcc
  v_lshlrev_b32 v3, 12, v3
  v_cndmask_b32 v49, v2, v3, s[70:71]
  v_add_u32 v1, 32, v7
  v_sub_u32 v3, 2048, v1
  s_cmp_lg_u32 s67, 0
  s_cselect_b64 vcc, -1, 0
  v_cmp_ge_u32 s[70:71], s74, v1
  v_cndmask_b32 v3, v1, v3, vcc
  v_lshlrev_b32 v3, 12, v3
  v_cndmask_b32 v50, v2, v3, s[70:71]
  v_add_u32 v1, 48, v7
  v_sub_u32 v3, 2048, v1
  s_cmp_lg_u32 s67, 0
  s_cselect_b64 vcc, -1, 0
  v_cmp_ge_u32 s[70:71], s74, v1
  v_cndmask_b32 v3, v1, v3, vcc
  v_lshlrev_b32 v3, 12, v3
  v_cndmask_b32 v51, v2, v3, s[70:71]
  v_add_u32 v1, 64, v7
  v_sub_u32 v3, 2048, v1
  s_cmp_lg_u32 s67, 0
  s_cselect_b64 vcc, -1, 0
  v_cmp_ge_u32 s[70:71], s74, v1
  v_cndmask_b32 v3, v1, v3, vcc
  v_lshlrev_b32 v3, 12, v3
  v_cndmask_b32 v52, v2, v3, s[70:71]
  v_add_u32 v1, 80, v7
  v_sub_u32 v3, 2048, v1
  s_cmp_lg_u32 s67, 0
  s_cselect_b64 vcc, -1, 0
  v_cmp_ge_u32 s[70:71], s74, v1
  v_cndmask_b32 v3, v1, v3, vcc
  v_lshlrev_b32 v3, 12, v3
  v_cndmask_b32 v53, v2, v3, s[70:71]
  v_add_u32 v1, 96, v7
  v_sub_u32 v3, 2048, v1
  s_cmp_lg_u32 s67, 0
  s_cselect_b64 vcc, -1, 0
  v_cmp_ge_u32 s[70:71], s74, v1
  v_cndmask_b32 v3, v1, v3, vcc
  v_lshlrev_b32 v3, 12, v3
  v_cndmask_b32 v54, v2, v3, s[70:71]
  v_add_u32 v1, 112, v7
  v_sub_u32 v3, 2048, v1
  s_cmp_lg_u32 s67, 0
  s_cselect_b64 vcc, -1, 0
  v_cmp_ge_u32 s[70:71], s74, v1
  v_cndmask_b32 v3, v1, v3, vcc
  v_lshlrev_b32 v3, 12, v3
  v_cndmask_b32 v55, v2, v3, s[70:71]
  v_add_u32 v1, v48, v11
  s_waitcnt lgkmcnt(15)
  buffer_store_dwordx4 v[104:107], v1, s[28:31], 0 offen
  v_add_u32 v1, v49, v11
  s_waitcnt lgkmcnt(14)
  buffer_store_dwordx4 v[108:111], v1, s[28:31], 0 offen
  v_add_u32 v1, v50, v11
  s_waitcnt lgkmcnt(13)
  buffer_store_dwordx4 v[112:115], v1, s[28:31], 0 offen
  v_add_u32 v1, v51, v11
  s_waitcnt lgkmcnt(12)
  buffer_store_dwordx4 v[116:119], v1, s[28:31], 0 offen
  v_add_u32 v1, v52, v11
  s_waitcnt lgkmcnt(11)
  buffer_store_dwordx4 v[120:123], v1, s[28:31], 0 offen
  v_add_u32 v1, v53, v11
  s_waitcnt lgkmcnt(10)
  buffer_store_dwordx4 v[124:127], v1, s[28:31], 0 offen
  v_add_u32 v1, v54, v11
  s_waitcnt lgkmcnt(9)
  buffer_store_dwordx4 v[128:131], v1, s[28:31], 0 offen
  v_add_u32 v1, v55, v11
  s_waitcnt lgkmcnt(8)
  buffer_store_dwordx4 v[132:135], v1, s[28:31], 0 offen
  s_cmp_eq_u64 s[72:73], 0
  s_cbranch_scc1 L_noedge_58
  s_waitcnt lgkmcnt(0)
  v_add_u32 v1, v48, v12
  buffer_store_short v40, v1, s[28:31], 0 offen
  v_add_u32 v1, v49, v12
  buffer_store_short v41, v1, s[28:31], 0 offen
  v_add_u32 v1, v50, v12
  buffer_store_short v42, v1, s[28:31], 0 offen
  v_add_u32 v1, v51, v12
  buffer_store_short v43, v1, s[28:31], 0 offen
  v_add_u32 v1, v52, v12
  buffer_store_short v44, v1, s[28:31], 0 offen
  v_add_u32 v1, v53, v12
  buffer_store_short v45, v1, s[28:31], 0 offen
  v_add_u32 v1, v54, v12
  buffer_store_short v46, v1, s[28:31], 0 offen
  v_add_u32 v1, v55, v12
  buffer_store_short v47, v1, s[28:31], 0 offen
L_noedge_58:
L_fin_55:
  s_add_u32 s56, s2, s42
  s_cmp_lg_u32 s56, 0
  s_cbranch_scc1 L_nz_59
  v_and_b32 v1, 31, v0
  v_lshlrev_b32 v1, 7, v1
  v_mov_b32 v8, 0
  v_mov_b32 v9, 0
  v_mov_b32 v10, 0
  v_mov_b32 v11, 0
  buffer_store_dwordx4 v[8:11], v1, s[32:35], 0 offen
L_nz_59:
L_end_49:
  s_endpgm
.section .rodata,"a"
.p2align 6
.amdhsa_kernel outp_kernel
  .amdhsa_next_free_vgpr 200
  .amdhsa_next_free_sgpr 96
  .amdhsa_accum_offset 200
  .amdhsa_group_segment_fixed_size 0
  .amdhsa_kernarg_size 104
  .amdhsa_user_sgpr_count 2
  .amdhsa_user_sgpr_kernarg_segment_ptr 1
  .amdhsa_system_sgpr_workgroup_id_x 1
.end_amdhsa_kernel
```
